```python
import torch

def _softmax(x, axis=-1):
    return torch.softmax(x, dim=axis)
def _gelu(x):
    return torch.nn.functional.gelu(x, approximate="tanh")
def _silu(x):
    return torch.nn.functional.silu(x)
def _sigmoid(x):
    return torch.sigmoid(x)
def _layernorm(x, axis=-1, eps=1e-5):
    m = x.mean(dim=axis, keepdim=True)
    v = x.var(dim=axis, keepdim=True, unbiased=False)
    return (x - m) / torch.sqrt(v + eps)
def _scatter_add(tgt, idx, src, axis=0):
    return tgt.clone().index_add_(axis, idx, src)
def _segment_sum(src, seg, n):
    out = torch.zeros((n,) + src.shape[1:], dtype=src.dtype)
    return out.index_add_(0, seg, src)
def _pad(x, pw):
    flat = tuple(v for pair in reversed(pw) for v in pair)
    return torch.nn.functional.pad(x, flat)

kernel_name = 'concat_heads__spectral_gfnet__ssm_conv_h3__prompt'

def setup_inputs():

    _w = (lambda a: (lambda t: t.to(torch.bfloat16) if t.is_floating_point() else t)(torch.as_tensor(a)))
    def _A_setup():
        B, S, D = 1, 2048, 1024
        Df = D // 2 + 1
        return {
            "x": _w((lambda *s: torch.randn(*s, dtype=torch.bfloat16) * 0.05)(B, S, D)),
            "w_r": _w((lambda *s: torch.randn(*s, dtype=torch.bfloat16) * 0.05)(S, Df) * 0.02),
            "w_i": _w((lambda *s: torch.randn(*s, dtype=torch.bfloat16) * 0.05)(S, Df) * 0.02),
        }
    _A_in = _A_setup()

    def _B_setup():
        B, S, D = 1, 2048, 1024
        ks = 4
        return {
            "q": _w((lambda *s: torch.randn(*s, dtype=torch.bfloat16) * 0.05)(B, S, D)),
            "k": _w((lambda *s: torch.randn(*s, dtype=torch.bfloat16) * 0.1)(B, S, D)),
            "v": _w((lambda *s: torch.randn(*s, dtype=torch.bfloat16) * 0.1)(B, S, D)),
            "shift_k": _w((lambda *s: torch.randn(*s, dtype=torch.bfloat16) * 0.1)(D, ks) * 0.5),
            "ssm_k": _w((lambda *s: torch.randn(*s, dtype=torch.bfloat16) * 0.1)(D, S) * (1.0 / S ** 0.5)),
            "ssm_D": _w((lambda *s: torch.randn(*s, dtype=torch.bfloat16) * 0.1)(D)),
        }
    _B_in = _B_setup()

    return {
        "A_x": _A_in["x"],
        "A_w_r": _A_in["w_r"],
        "A_w_i": _A_in["w_i"],
        "B_q": _B_in["q"],
        "B_k": _B_in["k"],
        "B_v": _B_in["v"],
        "B_shift_k": _B_in["shift_k"],
        "B_ssm_k": _B_in["ssm_k"],
        "B_ssm_D": _B_in["ssm_D"],
    }

def reference(A_x, A_w_r, A_w_i, B_q, B_k, B_v, B_shift_k, B_ssm_k, B_ssm_D):
    def _A_ref(x, w_r, w_i):
        B, S, D = x.shape
        X = (lambda x, axes=(-2,-1): torch.fft.rfft2(x.float(), dim=axes))(x, axes=(-2, -1))
        W = w_r + 1j * w_i
        X = X * W
        y = (lambda x, s, axes=(-2,-1): torch.fft.irfft2(x, s=s, dim=axes).to(torch.bfloat16))(X, (S, D), axes=(-2, -1))
        return y

    def _B_ref(q, k, v, shift_k, ssm_k, ssm_D):
        B, S, D = q.shape
        ks = shift_k.shape[-1]
        k_pad = _pad(k, ((0, 0), (ks - 1, 0), (0, 0)))
        k_shift = torch.zeros_like(k)
        for t in range(ks):
            k_shift = k_shift + k_pad[:, t:t + S, :] * shift_k[:, ks - 1 - t][None, None, :]
        kv = k_shift * v
        L = 2 * S
        kv_pad = _pad(kv, ((0, 0), (0, S), (0, 0)))
        kf_pad = _pad(ssm_k, ((0, 0), (0, S)))
        kv_f = (lambda x, axes=(-2,-1): torch.fft.rfft2(x.float(), dim=axes))(kv_pad[:, None, :, :], axes=(1, 2))
        kf_f = (lambda x, axes=(-2,-1): torch.fft.rfft2(x.float(), dim=axes))(kf_pad[:, None, :], axes=(1, 2))
        kf_f = (lambda x, *d: x.permute(*d))(kf_f, 1, 2, 0)
        y_f = kv_f * kf_f[None, :, :, :]
        y = (lambda x, s, axes=(-2,-1): torch.fft.irfft2(x, s=s, dim=axes).to(torch.bfloat16))(y_f, (1, L), axes=(1, 2))[:, 0, :S, :]
        y = y + kv * ssm_D[None, None, :]
        return q * y

    a = _A_ref(A_x, A_w_r, A_w_i)
    b = _B_ref(B_q, B_k, B_v, B_shift_k, B_ssm_k, B_ssm_D)
    return torch.concatenate([a, b], axis=-1)
```

```asm
; @launch grid=(512,1,1) block=(256,1,1) lds=73728
.amdgcn_target "amdgcn-amd-amdhsa--gfx950"
.text
.globl concat_heads__spectral_gfnet__ssm_conv_h3__prompt_kernel
.p2align 8
.type concat_heads__spectral_gfnet__ssm_conv_h3__prompt_kernel,@function
concat_heads__spectral_gfnet__ssm_conv_h3__prompt_kernel:
    s_cmp_ge_u32 s2, 512
    s_cbranch_scc1 L_end
    s_load_dwordx16 s[4:19], s[0:1], 0
    s_load_dwordx8 s[20:27], s[0:1], 64
    v_and_b32 v1, 63, v0
    s_getpc_b64 s[30:31]
L_pc:
    s_sub_u32 s30, s30, L_pc-concat_heads__spectral_gfnet__ssm_conv_h3__prompt_kernel
    s_subb_u32 s31, s31, 0
    s_bfe_u32 s28, s2, 0x50003
    s_lshl_b32 s28, s28, 10
    s_cmp_ge_u32 s28, L_end-concat_heads__spectral_gfnet__ssm_conv_h3__prompt_kernel-1024
    s_cbranch_scc1 L_nopf
    v_cmp_gt_u32 vcc, 64, v0
    s_nop 4
    s_cbranch_vccz L_nopf
    v_lshlrev_b32 v3, 4, v1
    v_add_u32 v3, s28, v3
    global_load_dwordx4 v[248:251], v3, s[30:31]
    s_nop 3
L_nopf:
    v_lshrrev_b32 v2, 6, v0
    s_nop 0
    v_readfirstlane_b32 s68, v2
    s_waitcnt lgkmcnt(0)
    s_mov_b32 s52, s24
    s_and_b32 s53, s25, 0xffff
    s_mov_b32 s54, 256
    s_mov_b32 s55, 0x20000
    s_or_b32 s70, s2, s68
    s_cmp_lg_u32 s70, 0
    s_cbranch_scc1 L_nomaster
    s_memrealtime s[74:75]
    s_waitcnt lgkmcnt(0)
    s_or_b32 s74, s74, 1
    v_mov_b32 v3, s74
    v_lshlrev_b32 v4, 2, v1
    buffer_store_dword v3, v4, s[52:55], 0 offen sc1
    s_nop 3
L_nomaster:
    s_cmp_ge_u32 s2, 256
    s_cbranch_scc1 L_role_b
    s_setprio 3
    s_mov_b32 s32, s4
    s_and_b32 s33, s5, 0xffff
    s_mov_b32 s34, 4194304
    s_mov_b32 s35, 0x20000
    v_lshlrev_b32 v2, 4, v1
    s_lshl_b32 s70, s68, 19
    s_lshl_b32 s71, s2, 11
    s_add_u32 s70, s70, s71
    s_lshl_b32 s71, s68, 11
    s_add_u32 m0, s71, 0
    s_nop 0
    buffer_load_dwordx4 v2, s[32:35], s70 offen offset:0 nt lds
    buffer_load_dwordx4 v2, s[32:35], s70 offen offset:1024 nt lds
    s_add_u32 s70, s70, 2097152
    s_add_u32 m0, s71, 8192
    s_nop 0
    buffer_load_dwordx4 v2, s[32:35], s70 offen offset:0 nt lds
    buffer_load_dwordx4 v2, s[32:35], s70 offen offset:1024 nt lds
    s_mov_b32 s36, s6
    s_and_b32 s37, s7, 0xffff
    s_mov_b32 s38, 2101248
    s_mov_b32 s39, 0x20000
    s_mov_b32 s40, s8
    s_and_b32 s41, s9, 0xffff
    s_mov_b32 s42, 2101248
    s_mov_b32 s43, 0x20000
    s_and_b32 s76, s2, 7
    s_lshr_b32 s77, s2, 3
    s_mov_b32 s44, s22
    s_and_b32 s45, s23, 0xffff
    s_mov_b32 s46, 8388608
    s_mov_b32 s47, 0x20000
    s_mov_b32 s48, s26
    s_and_b32 s49, s27, 0xffff
    s_mov_b32 s50, 27262976
    s_mov_b32 s51, 0x20000
    v_and_b32 v8, 31, v1
    v_lshrrev_b32 v9, 5, v1
    v_lshlrev_b32 v10, 2, v9
    v_mul_u32_u24 v10, v10, v8
    v_and_b32 v11, 1, v8
    v_mul_u32_u24 v11, 0x8000, v11
    v_lshl_or_b32 v11, v11, 16, v11
    v_mad_u32_u24 v2, v8, 0, v10
    v_and_b32 v2, 31, v2
    v_cvt_f32_u32 v3, v2
    v_mul_f32 v3, 0x3d000000, v3
    v_cos_f32 v96, v3
    v_sin_f32 v104, v3
    v_mad_u32_u24 v2, v8, 1, v10
    v_and_b32 v2, 31, v2
    v_cvt_f32_u32 v3, v2
    v_mul_f32 v3, 0x3d000000, v3
    v_cos_f32 v97, v3
    v_sin_f32 v105, v3
    v_mad_u32_u24 v2, v8, 2, v10
    v_and_b32 v2, 31, v2
    v_cvt_f32_u32 v3, v2
    v_mul_f32 v3, 0x3d000000, v3
    v_cos_f32 v98, v3
    v_sin_f32 v106, v3
    v_mad_u32_u24 v2, v8, 3, v10
    v_and_b32 v2, 31, v2
    v_cvt_f32_u32 v3, v2
    v_mul_f32 v3, 0x3d000000, v3
    v_cos_f32 v99, v3
    v_sin_f32 v107, v3
    v_mad_u32_u24 v2, v8, 8, v10
    v_and_b32 v2, 31, v2
    v_cvt_f32_u32 v3, v2
    v_mul_f32 v3, 0x3d000000, v3
    v_cos_f32 v100, v3
    v_sin_f32 v108, v3
    v_mad_u32_u24 v2, v8, 9, v10
    v_and_b32 v2, 31, v2
    v_cvt_f32_u32 v3, v2
    v_mul_f32 v3, 0x3d000000, v3
    v_cos_f32 v101, v3
    v_sin_f32 v109, v3
    v_mad_u32_u24 v2, v8, 10, v10
    v_and_b32 v2, 31, v2
    v_cvt_f32_u32 v3, v2
    v_mul_f32 v3, 0x3d000000, v3
    v_cos_f32 v102, v3
    v_sin_f32 v110, v3
    v_mad_u32_u24 v2, v8, 11, v10
    v_and_b32 v2, 31, v2
    v_cvt_f32_u32 v3, v2
    v_mul_f32 v3, 0x3d000000, v3
    v_cos_f32 v103, v3
    v_sin_f32 v111, v3
    v_cvt_pk_bf16_f32 v16, v96, v97
    v_cvt_pk_bf16_f32 v24, v104, v105
    v_cvt_pk_bf16_f32 v17, v98, v99
    v_cvt_pk_bf16_f32 v25, v106, v107
    v_cvt_pk_bf16_f32 v18, v100, v101
    v_cvt_pk_bf16_f32 v26, v108, v109
    v_cvt_pk_bf16_f32 v19, v102, v103
    v_cvt_pk_bf16_f32 v27, v110, v111
    s_mov_b32 s70, 0x80008000
    v_xor_b32 v32, s70, v24
    v_xor_b32 v20, v11, v16
    v_xor_b32 v28, v11, v24
    v_xor_b32 v33, s70, v25
    v_xor_b32 v21, v11, v17
    v_xor_b32 v29, v11, v25
    v_xor_b32 v34, s70, v26
    v_xor_b32 v22, v11, v18
    v_xor_b32 v30, v11, v26
    v_xor_b32 v35, s70, v27
    v_xor_b32 v23, v11, v19
    v_xor_b32 v31, v11, v27
    v_xor_b32 v36, v11, v32
    v_xor_b32 v37, v11, v33
    v_xor_b32 v38, v11, v34
    v_xor_b32 v39, v11, v35
    v_mad_u32_u24 v2, v8, 0, v10
    v_cvt_f32_u32 v2, v2
    v_mul_f32 v2, 0xba800000, v2
    v_cos_f32 v40, v2
    v_sin_f32 v56, v2
    v_mad_u32_u24 v2, v8, 1, v10
    v_cvt_f32_u32 v2, v2
    v_mul_f32 v2, 0xba800000, v2
    v_cos_f32 v41, v2
    v_sin_f32 v57, v2
    v_mad_u32_u24 v2, v8, 2, v10
    v_cvt_f32_u32 v2, v2
    v_mul_f32 v2, 0xba800000, v2
    v_cos_f32 v42, v2
    v_sin_f32 v58, v2
    v_mad_u32_u24 v2, v8, 3, v10
    v_cvt_f32_u32 v2, v2
    v_mul_f32 v2, 0xba800000, v2
    v_cos_f32 v43, v2
    v_sin_f32 v59, v2
    v_mad_u32_u24 v2, v8, 8, v10
    v_cvt_f32_u32 v2, v2
    v_mul_f32 v2, 0xba800000, v2
    v_cos_f32 v44, v2
    v_sin_f32 v60, v2
    v_mad_u32_u24 v2, v8, 9, v10
    v_cvt_f32_u32 v2, v2
    v_mul_f32 v2, 0xba800000, v2
    v_cos_f32 v45, v2
    v_sin_f32 v61, v2
    v_mad_u32_u24 v2, v8, 10, v10
    v_cvt_f32_u32 v2, v2
    v_mul_f32 v2, 0xba800000, v2
    v_cos_f32 v46, v2
    v_sin_f32 v62, v2
    v_mad_u32_u24 v2, v8, 11, v10
    v_cvt_f32_u32 v2, v2
    v_mul_f32 v2, 0xba800000, v2
    v_cos_f32 v47, v2
    v_sin_f32 v63, v2
    v_mad_u32_u24 v2, v8, 16, v10
    v_cvt_f32_u32 v2, v2
    v_mul_f32 v2, 0xba800000, v2
    v_cos_f32 v48, v2
    v_sin_f32 v64, v2
    v_mad_u32_u24 v2, v8, 17, v10
    v_cvt_f32_u32 v2, v2
    v_mul_f32 v2, 0xba800000, v2
    v_cos_f32 v49, v2
    v_sin_f32 v65, v2
    v_mad_u32_u24 v2, v8, 18, v10
    v_cvt_f32_u32 v2, v2
    v_mul_f32 v2, 0xba800000, v2
    v_cos_f32 v50, v2
    v_sin_f32 v66, v2
    v_mad_u32_u24 v2, v8, 19, v10
    v_cvt_f32_u32 v2, v2
    v_mul_f32 v2, 0xba800000, v2
    v_cos_f32 v51, v2
    v_sin_f32 v67, v2
    v_mad_u32_u24 v2, v8, 24, v10
    v_cvt_f32_u32 v2, v2
    v_mul_f32 v2, 0xba800000, v2
    v_cos_f32 v52, v2
    v_sin_f32 v68, v2
    v_mad_u32_u24 v2, v8, 25, v10
    v_cvt_f32_u32 v2, v2
    v_mul_f32 v2, 0xba800000, v2
    v_cos_f32 v53, v2
    v_sin_f32 v69, v2
    v_mad_u32_u24 v2, v8, 26, v10
    v_cvt_f32_u32 v2, v2
    v_mul_f32 v2, 0xba800000, v2
    v_cos_f32 v54, v2
    v_sin_f32 v70, v2
    v_mad_u32_u24 v2, v8, 27, v10
    v_cvt_f32_u32 v2, v2
    v_mul_f32 v2, 0xba800000, v2
    v_cos_f32 v55, v2
    v_sin_f32 v71, v2
    v_and_b32 v2, 7, v1
    v_lshrrev_b32 v3, 4, v1
    v_bfe_u32 v12, v1, 3, 1
    v_lshrrev_b32 v13, 5, v1
    v_cmp_eq_u32 vcc, v12, v13
    v_mov_b32 v14, 0.5
    s_nop 0
    v_cndmask_b32 v4, 0, v14, vcc
    v_lshlrev_b32 v12, 31, v2
    v_and_b32 v13, 1, v3
    v_xor_b32 v13, 1, v13
    v_lshlrev_b32 v13, 31, v13
    v_xor_b32 v6, v12, v4
    v_xor_b32 v5, v13, v6
    v_xor_b32 v7, v13, v4
    v_xor_b32 v7, 0x80000000, v7
    s_add_u32 s70, s2, 0
    v_mul_u32_u24 v12, s70, v2
    v_and_b32 v12, 0x7ff, v12
    v_cvt_f32_u32 v15, v12
    v_mul_f32 v15, 0x3a000000, v15
    v_cos_f32 v13, v15
    v_sin_f32 v14, v15
    v_mul_f32 v96, v4, v13
    v_mul_f32 v97, v6, v13
    v_mul_f32 v104, v5, v13
    v_mul_f32 v105, v7, v13
    v_fma_f32 v96, v5, v14, v96
    v_fma_f32 v97, v7, v14, v97
    v_fma_f32 v104, -v4, v14, v104
    v_fma_f32 v105, -v6, v14, v105
    s_add_u32 s70, s2, 256
    v_mul_u32_u24 v12, s70, v2
    v_and_b32 v12, 0x7ff, v12
    v_cvt_f32_u32 v15, v12
    v_mul_f32 v15, 0x3a000000, v15
    v_cos_f32 v13, v15
    v_sin_f32 v14, v15
    v_mul_f32 v98, v4, v13
    v_mul_f32 v99, v6, v13
    v_mul_f32 v106, v5, v13
    v_mul_f32 v107, v7, v13
    v_fma_f32 v98, v5, v14, v98
    v_fma_f32 v99, v7, v14, v99
    v_fma_f32 v106, -v4, v14, v106
    v_fma_f32 v107, -v6, v14, v107
    s_add_u32 s70, s2, 512
    v_mul_u32_u24 v12, s70, v2
    v_and_b32 v12, 0x7ff, v12
    v_cvt_f32_u32 v15, v12
    v_mul_f32 v15, 0x3a000000, v15
    v_cos_f32 v13, v15
    v_sin_f32 v14, v15
    v_mul_f32 v100, v4, v13
    v_mul_f32 v101, v6, v13
    v_mul_f32 v108, v5, v13
    v_mul_f32 v109, v7, v13
    v_fma_f32 v100, v5, v14, v100
    v_fma_f32 v101, v7, v14, v101
    v_fma_f32 v108, -v4, v14, v108
    v_fma_f32 v109, -v6, v14, v109
    s_add_u32 s70, s2, 768
    v_mul_u32_u24 v12, s70, v2
    v_and_b32 v12, 0x7ff, v12
    v_cvt_f32_u32 v15, v12
    v_mul_f32 v15, 0x3a000000, v15
    v_cos_f32 v13, v15
    v_sin_f32 v14, v15
    v_mul_f32 v102, v4, v13
    v_mul_f32 v103, v6, v13
    v_mul_f32 v110, v5, v13
    v_mul_f32 v111, v7, v13
    v_fma_f32 v102, v5, v14, v102
    v_fma_f32 v103, v7, v14, v103
    v_fma_f32 v110, -v4, v14, v110
    v_fma_f32 v111, -v6, v14, v111
    v_cvt_pk_bf16_f32 v88, v96, v97
    v_cvt_pk_bf16_f32 v92, v104, v105
    v_cvt_pk_bf16_f32 v89, v98, v99
    v_cvt_pk_bf16_f32 v93, v106, v107
    v_cvt_pk_bf16_f32 v90, v100, v101
    v_cvt_pk_bf16_f32 v94, v108, v109
    v_cvt_pk_bf16_f32 v91, v102, v103
    v_cvt_pk_bf16_f32 v95, v110, v111
    v_bfe_u32 v3, v1, 2, 2
    v_lshrrev_b32 v4, 5, v1
    v_lshl_add_u32 v3, v4, 2, v3
    v_lshlrev_b32 v2, 6, v3
    v_bfe_u32 v3, v1, 4, 1
    v_lshl_add_u32 v2, v3, 5, v2
    v_and_b32 v3, 3, v1
    v_lshl_add_u32 v2, v3, 3, v2
    s_lshl_b32 s70, s68, 11
    v_add_u32 v2, s70, v2
    s_waitcnt vmcnt(0)
    s_and_b32 s70, s2, 63
    s_lshl_b32 s70, s70, 2
    v_mov_b32 v3, s70
    buffer_load_dword v218, v3, s[52:55], 0 offen sc1
    s_cmp_lg_u32 s68, 0
    s_cbranch_scc1 L_a1_wn_ld
    s_lshl_b32 s70, s2, 3
    s_mul_i32 s70, s70, 1026
    s_add_u32 s70, s70, 1024
    v_mul_u32_u24 v3, 1026, v1
    s_mov_b64 exec, 0xff
    buffer_load_ushort v160, v3, s[36:39], s70 offen
    buffer_load_ushort v161, v3, s[40:43], s70 offen
    s_mov_b64 exec, -1
    s_nop 1
L_a1_wn_ld:
    ds_read_b64_tr_b16 v[72:73], v2 offset:0
    ds_read_b64_tr_b16 v[74:75], v2 offset:512
    ds_read_b64_tr_b16 v[76:77], v2 offset:1024
    ds_read_b64_tr_b16 v[78:79], v2 offset:1536
    ds_read_b64_tr_b16 v[80:81], v2 offset:8192
    ds_read_b64_tr_b16 v[82:83], v2 offset:8704
    ds_read_b64_tr_b16 v[84:85], v2 offset:9216
    ds_read_b64_tr_b16 v[86:87], v2 offset:9728
    s_waitcnt lgkmcnt(6)
    v_mfma_f32_32x32x16_bf16 v[96:111], v[72:75], v[16:19], 0
    s_waitcnt lgkmcnt(2)
    v_mfma_f32_32x32x16_bf16 v[112:127], v[80:83], v[16:19], 0
    v_mfma_f32_32x32x16_bf16 v[96:111], v[76:79], v[20:23], v[96:111]
    s_waitcnt lgkmcnt(0)
    v_mfma_f32_32x32x16_bf16 v[112:127], v[84:87], v[20:23], v[112:127]
    v_mfma_f32_32x32x16_bf16 v[96:111], v[80:83], v[24:27], v[96:111]
    v_mfma_f32_32x32x16_bf16 v[112:127], v[72:75], v[32:35], v[112:127]
    v_mfma_f32_32x32x16_bf16 v[96:111], v[84:87], v[28:31], v[96:111]
    v_mfma_f32_32x32x16_bf16 v[112:127], v[76:79], v[36:39], v[112:127]
    s_nop 11
    v_pk_mul_f32 v[4:5], v[112:113], v[56:57]
    v_pk_mul_f32 v[6:7], v[112:113], v[40:41]
    v_pk_fma_f32 v[144:145], v[96:97], v[56:57], v[6:7]
    v_pk_fma_f32 v[128:129], v[96:97], v[40:41], v[4:5] neg_lo:[0,0,1] neg_hi:[0,0,1]
    v_pk_mul_f32 v[4:5], v[114:115], v[58:59]
    v_pk_mul_f32 v[6:7], v[114:115], v[42:43]
    v_pk_fma_f32 v[146:147], v[98:99], v[58:59], v[6:7]
    v_pk_fma_f32 v[130:131], v[98:99], v[42:43], v[4:5] neg_lo:[0,0,1] neg_hi:[0,0,1]
    v_pk_mul_f32 v[4:5], v[116:117], v[60:61]
    v_pk_mul_f32 v[6:7], v[116:117], v[44:45]
    v_pk_fma_f32 v[148:149], v[100:101], v[60:61], v[6:7]
    v_pk_fma_f32 v[132:133], v[100:101], v[44:45], v[4:5] neg_lo:[0,0,1] neg_hi:[0,0,1]
    v_pk_mul_f32 v[4:5], v[118:119], v[62:63]
    v_pk_mul_f32 v[6:7], v[118:119], v[46:47]
    v_pk_fma_f32 v[150:151], v[102:103], v[62:63], v[6:7]
    v_pk_fma_f32 v[134:135], v[102:103], v[46:47], v[4:5] neg_lo:[0,0,1] neg_hi:[0,0,1]
    v_pk_mul_f32 v[4:5], v[120:121], v[64:65]
    v_pk_mul_f32 v[6:7], v[120:121], v[48:49]
    v_pk_fma_f32 v[152:153], v[104:105], v[64:65], v[6:7]
    v_pk_fma_f32 v[136:137], v[104:105], v[48:49], v[4:5] neg_lo:[0,0,1] neg_hi:[0,0,1]
    v_pk_mul_f32 v[4:5], v[122:123], v[66:67]
    v_pk_mul_f32 v[6:7], v[122:123], v[50:51]
    v_pk_fma_f32 v[154:155], v[106:107], v[66:67], v[6:7]
    v_pk_fma_f32 v[138:139], v[106:107], v[50:51], v[4:5] neg_lo:[0,0,1] neg_hi:[0,0,1]
    v_pk_mul_f32 v[4:5], v[124:125], v[68:69]
    v_pk_mul_f32 v[6:7], v[124:125], v[52:53]
    v_pk_fma_f32 v[156:157], v[108:109], v[68:69], v[6:7]
    v_pk_fma_f32 v[140:141], v[108:109], v[52:53], v[4:5] neg_lo:[0,0,1] neg_hi:[0,0,1]
    v_pk_mul_f32 v[4:5], v[126:127], v[70:71]
    v_pk_mul_f32 v[6:7], v[126:127], v[54:55]
    v_pk_fma_f32 v[158:159], v[110:111], v[70:71], v[6:7]
    v_pk_fma_f32 v[142:143], v[110:111], v[54:55], v[4:5] neg_lo:[0,0,1] neg_hi:[0,0,1]
    v_cvt_pk_bf16_f32 v72, v128, v129
    v_cvt_pk_bf16_f32 v80, v144, v145
    v_cvt_pk_bf16_f32 v73, v130, v131
    v_cvt_pk_bf16_f32 v81, v146, v147
    v_cvt_pk_bf16_f32 v74, v132, v133
    v_cvt_pk_bf16_f32 v82, v148, v149
    v_cvt_pk_bf16_f32 v75, v134, v135
    v_cvt_pk_bf16_f32 v83, v150, v151
    v_cvt_pk_bf16_f32 v76, v136, v137
    v_cvt_pk_bf16_f32 v84, v152, v153
    v_cvt_pk_bf16_f32 v77, v138, v139
    v_cvt_pk_bf16_f32 v85, v154, v155
    v_cvt_pk_bf16_f32 v78, v140, v141
    v_cvt_pk_bf16_f32 v86, v156, v157
    v_cvt_pk_bf16_f32 v79, v142, v143
    v_cvt_pk_bf16_f32 v87, v158, v159
    v_mfma_f32_32x32x16_bf16 v[96:111], v[16:19], v[72:75], 0
    v_mfma_f32_32x32x16_bf16 v[112:127], v[16:19], v[80:83], 0
    v_mfma_f32_32x32x16_bf16 v[96:111], v[20:23], v[76:79], v[96:111]
    v_mfma_f32_32x32x16_bf16 v[112:127], v[20:23], v[84:87], v[112:127]
    v_mfma_f32_32x32x16_bf16 v[96:111], v[24:27], v[80:83], v[96:111]
    v_mfma_f32_32x32x16_bf16 v[112:127], v[32:35], v[72:75], v[112:127]
    v_mfma_f32_32x32x16_bf16 v[96:111], v[28:31], v[84:87], v[96:111]
    v_mfma_f32_32x32x16_bf16 v[112:127], v[36:39], v[76:79], v[112:127]
    v_lshlrev_b32 v2, 4, v8
    v_lshl_add_u32 v2, v9, 11, v2
    s_lshl_b32 s70, s68, 2
    v_add_u32 v2, s70, v2
    s_nop 7
    v_cvt_pk_bf16_f32 v128, v96, v112
    v_cvt_pk_bf16_f32 v129, v97, v113
    v_cvt_pk_bf16_f32 v130, v98, v114
    v_cvt_pk_bf16_f32 v131, v99, v115
    v_cvt_pk_bf16_f32 v132, v100, v116
    v_cvt_pk_bf16_f32 v133, v101, v117
    v_cvt_pk_bf16_f32 v134, v102, v118
    v_cvt_pk_bf16_f32 v135, v103, v119
    v_cvt_pk_bf16_f32 v136, v104, v120
    v_cvt_pk_bf16_f32 v137, v105, v121
    v_cvt_pk_bf16_f32 v138, v106, v122
    v_cvt_pk_bf16_f32 v139, v107, v123
    v_cvt_pk_bf16_f32 v140, v108, v124
    v_cvt_pk_bf16_f32 v141, v109, v125
    v_cvt_pk_bf16_f32 v142, v110, v126
    v_cvt_pk_bf16_f32 v143, v111, v127
    ds_write_b32 v2, v128 offset:16384
    ds_write_b32 v2, v129 offset:16896
    ds_write_b32 v2, v130 offset:17408
    ds_write_b32 v2, v131 offset:17920
    ds_write_b32 v2, v132 offset:20480
    ds_write_b32 v2, v133 offset:20992
    ds_write_b32 v2, v134 offset:21504
    ds_write_b32 v2, v135 offset:22016
    ds_write_b32 v2, v136 offset:24576
    ds_write_b32 v2, v137 offset:25088
    ds_write_b32 v2, v138 offset:25600
    ds_write_b32 v2, v139 offset:26112
    ds_write_b32 v2, v140 offset:28672
    ds_write_b32 v2, v141 offset:29184
    ds_write_b32 v2, v142 offset:29696
    ds_write_b32 v2, v143 offset:30208
    v_and_b32 v12, 15, v1
    v_lshrrev_b32 v13, 5, v1
    v_lshl_add_u32 v12, v13, 4, v12
    v_lshlrev_b32 v12, 4, v12
    s_lshl_b32 s70, s68, 9
    v_add_u32 v12, s70, v12
    v_sub_u32 v13, 0x4000, v12
    v_bfe_u32 v14, v1, 4, 1
    v_cmp_eq_u32 vcc, 1, v14
    s_nop 1
    v_cndmask_b32 v4, v12, v13, vcc
    v_mov_b32 v12, 0x800
    v_mov_b32 v13, 0xfffff800
    v_cndmask_b32 v5, v12, v13, vcc
    v_and_b32 v4, 0x3fff, v4
    v_and_b32 v12, 7, v1
    v_lshlrev_b32 v6, 19, v12
    v_bfe_u32 v12, v1, 3, 1
    v_lshl_add_u32 v6, v12, 14, v6
    v_lshrrev_b32 v12, 4, v1
    v_lshl_add_u32 v6, v12, 4, v6
    s_and_b32 s70, s2, 15
    s_lshl_b32 s78, s70, 2
    s_lshr_b32 s70, s2, 6
    s_lshl_b32 s70, s70, 6
    s_add_u32 s78, s78, s70
    s_bfe_u32 s70, s2, 0x20004
    s_add_u32 s78, s78, s70
    s_lshl_b32 s79, s78, 6
    s_lshl_b32 s70, s68, 15
    s_add_u32 s79, s79, s70
    s_waitcnt lgkmcnt(0)
    s_barrier
    ds_read_b128 v[96:99], v4 offset:16384
    v_add_u32 v4, v5, v4
    v_and_b32 v4, 0x3fff, v4
    ds_read_b128 v[100:103], v4 offset:16384
    v_add_u32 v4, v5, v4
    v_and_b32 v4, 0x3fff, v4
    ds_read_b128 v[104:107], v4 offset:16384
    v_add_u32 v4, v5, v4
    v_and_b32 v4, 0x3fff, v4
    ds_read_b128 v[108:111], v4 offset:16384
    v_add_u32 v4, v5, v4
    v_and_b32 v4, 0x3fff, v4
    ds_read_b128 v[112:115], v4 offset:16384
    s_waitcnt lgkmcnt(4)
    v_mfma_f32_16x16x32_bf16 v[116:119], v[96:99], v[88:91], 0
    v_mfma_f32_16x16x32_bf16 v[120:123], v[96:99], v[92:95], 0
    s_waitcnt lgkmcnt(3)
    v_mfma_f32_16x16x32_bf16 v[124:127], v[100:103], v[88:91], 0
    v_mfma_f32_16x16x32_bf16 v[128:131], v[100:103], v[92:95], 0
    s_waitcnt lgkmcnt(2)
    v_mfma_f32_16x16x32_bf16 v[132:135], v[104:107], v[88:91], 0
    v_mfma_f32_16x16x32_bf16 v[136:139], v[104:107], v[92:95], 0
    s_waitcnt lgkmcnt(1)
    v_mfma_f32_16x16x32_bf16 v[140:143], v[108:111], v[88:91], 0
    v_mfma_f32_16x16x32_bf16 v[144:147], v[108:111], v[92:95], 0
    s_waitcnt lgkmcnt(0)
    v_mfma_f32_16x16x32_bf16 v[148:151], v[112:115], v[88:91], 0
    v_mfma_f32_16x16x32_bf16 v[152:155], v[112:115], v[92:95], 0
    v_cvt_pk_bf16_f32 v164, v116, v120
    v_cvt_pk_bf16_f32 v165, v117, v121
    v_cvt_pk_bf16_f32 v166, v118, v122
    v_cvt_pk_bf16_f32 v167, v119, v123
    buffer_store_dwordx4 v[164:167], v6, s[48:51], s79 offen sc1
    s_add_u32 s79, s79, 131072
    v_cvt_pk_bf16_f32 v168, v124, v128
    v_cvt_pk_bf16_f32 v169, v125, v129
    v_cvt_pk_bf16_f32 v170, v126, v130
    v_cvt_pk_bf16_f32 v171, v127, v131
    buffer_store_dwordx4 v[168:171], v6, s[48:51], s79 offen sc1
    s_add_u32 s79, s79, 131072
    v_cvt_pk_bf16_f32 v172, v132, v136
    v_cvt_pk_bf16_f32 v173, v133, v137
    v_cvt_pk_bf16_f32 v174, v134, v138
    v_cvt_pk_bf16_f32 v175, v135, v139
    buffer_store_dwordx4 v[172:175], v6, s[48:51], s79 offen sc1
    s_add_u32 s79, s79, 131072
    v_cvt_pk_bf16_f32 v176, v140, v144
    v_cvt_pk_bf16_f32 v177, v141, v145
    v_cvt_pk_bf16_f32 v178, v142, v146
    v_cvt_pk_bf16_f32 v179, v143, v147
    buffer_store_dwordx4 v[176:179], v6, s[48:51], s79 offen sc1
    s_cmp_lg_u32 s68, 0
    s_cbranch_scc1 L_a1_nyq_done
    v_lshlrev_b32 v12, 10, v1
    s_lshl_b32 s70, s78, 2
    s_add_u32 s70, s70, 4194304
    v_cvt_pk_bf16_f32 v13, v148, v152
    s_waitcnt vmcnt(4)
    v_lshl_or_b32 v14, v161, 16, v160
    s_lshl_b32 s71, s2, 2
    s_add_u32 s71, s71, 25165824
    s_mov_b64 exec, 0xff
    buffer_store_dword v13, v12, s[48:51], s70 offen sc1
    buffer_store_dword v14, v12, s[48:51], s71 offen sc1
    s_mov_b64 exec, -1
    s_nop 1
L_a1_nyq_done:
    s_waitcnt vmcnt(0)
    s_cmp_lg_u32 s68, 0
    s_cbranch_scc1 L_nonce_skip_a
    v_readfirstlane_b32 s69, v218
    s_nop 3
    s_cmp_lg_u32 s69, 0
    s_cbranch_scc1 L_nonce_skip_a
    s_and_b32 s70, s2, 63
    s_lshl_b32 s70, s70, 2
    v_mov_b32 v12, s70
    s_mov_b32 s92, 0
    s_nop 3
L_nonce_a:
    buffer_load_dword v13, v12, s[52:55], 0 offen sc1
    s_waitcnt vmcnt(0)
    v_readfirstlane_b32 s69, v13
    s_add_u32 s92, s92, 1
    s_cmp_gt_u32 s92, 400000
    s_cbranch_scc1 L_nonce_done_a
    s_nop 0
    s_cmp_eq_u32 s69, 0
    s_cbranch_scc0 L_nonce_done_a
    s_sleep 4
    s_branch L_nonce_a
L_nonce_done_a:
    s_nop 1
L_nonce_skip_a:
    s_barrier
    s_cmp_lg_u32 s68, 0
    s_cbranch_scc1 L_sig_skip_a1
    s_lshl_b32 s70, s2, 2
    s_add_u32 s70, s70, 26214400
    v_lshlrev_b32 v12, 10, v1
    v_add_u32 v12, s70, v12
    v_mov_b32 v13, s69
    s_mov_b64 s[90:91], exec
    s_mov_b64 exec, 0xffff
    buffer_store_dword v13, v12, s[48:51], 0 offen sc1
    s_mov_b64 exec, s[90:91]
    s_nop 1
L_sig_skip_a1:
    v_and_b32 v8, 15, v1
    v_lshrrev_b32 v9, 4, v1
    v_lshlrev_b32 v10, 2, v9
    v_mul_u32_u24 v10, v10, v8
    v_mad_u32_u24 v2, v8, 0, v10
    v_and_b32 v3, 15, v2
    v_cvt_f32_u32 v6, v3
    v_mul_f32 v6, 0x3d800000, v6
    v_cos_f32 v4, v6
    v_sin_f32 v5, v6
    s_nop 0
    v_cvt_pk_bf16_f32 v16, v4, v5
    v_cvt_pk_bf16_f32 v20, -v5, v4
    v_cvt_pk_bf16_f32 v24, v4, -v5
    v_cvt_pk_bf16_f32 v28, v5, v4
    v_cvt_f32_u32 v6, v2
    v_mul_f32 v6, 0xbb800000, v6
    v_cos_f32 v32, v6
    v_sin_f32 v36, v6
    v_mad_u32_u24 v2, v8, 1, v10
    v_and_b32 v3, 15, v2
    v_cvt_f32_u32 v6, v3
    v_mul_f32 v6, 0x3d800000, v6
    v_cos_f32 v4, v6
    v_sin_f32 v5, v6
    s_nop 0
    v_cvt_pk_bf16_f32 v17, v4, v5
    v_cvt_pk_bf16_f32 v21, -v5, v4
    v_cvt_pk_bf16_f32 v25, v4, -v5
    v_cvt_pk_bf16_f32 v29, v5, v4
    v_cvt_f32_u32 v6, v2
    v_mul_f32 v6, 0xbb800000, v6
    v_cos_f32 v33, v6
    v_sin_f32 v37, v6
    v_mad_u32_u24 v2, v8, 2, v10
    v_and_b32 v3, 15, v2
    v_cvt_f32_u32 v6, v3
    v_mul_f32 v6, 0x3d800000, v6
    v_cos_f32 v4, v6
    v_sin_f32 v5, v6
    s_nop 0
    v_cvt_pk_bf16_f32 v18, v4, v5
    v_cvt_pk_bf16_f32 v22, -v5, v4
    v_cvt_pk_bf16_f32 v26, v4, -v5
    v_cvt_pk_bf16_f32 v30, v5, v4
    v_cvt_f32_u32 v6, v2
    v_mul_f32 v6, 0xbb800000, v6
    v_cos_f32 v34, v6
    v_sin_f32 v38, v6
    v_mad_u32_u24 v2, v8, 3, v10
    v_and_b32 v3, 15, v2
    v_cvt_f32_u32 v6, v3
    v_mul_f32 v6, 0x3d800000, v6
    v_cos_f32 v4, v6
    v_sin_f32 v5, v6
    s_nop 0
    v_cvt_pk_bf16_f32 v19, v4, v5
    v_cvt_pk_bf16_f32 v23, -v5, v4
    v_cvt_pk_bf16_f32 v27, v4, -v5
    v_cvt_pk_bf16_f32 v31, v5, v4
    v_cvt_f32_u32 v6, v2
    v_mul_f32 v6, 0xbb800000, v6
    v_cos_f32 v35, v6
    v_sin_f32 v39, v6
    v_xor_b32 v2, v8, v9
    v_lshlrev_b32 v2, 4, v2
    v_lshl_add_u32 v40, v9, 8, v2
    v_xor_b32 v41, 64, v40
    v_xor_b32 v42, 128, v40
    v_xor_b32 v43, 192, v40
    v_xor_b32 v2, s68, v8
    v_lshlrev_b32 v2, 4, v2
    v_lshl_add_u32 v44, v1, 8, v2
    v_xor_b32 v45, 64, v44
    v_xor_b32 v46, 128, v44
    v_xor_b32 v47, 192, v44
    v_lshlrev_b32 v48, 5, v8
    v_lshl_add_u32 v48, v9, 11, v48
    s_lshl_b32 s70, s68, 3
    v_add_u32 v48, s70, v48
    s_cmp_eq_u32 s68, 0
    s_cbranch_scc1 L_a_wdone
    v_lshrrev_b32 v3, 1, v1
    v_mul_u32_u24 v3, 8208, v3
    v_and_b32 v4, 1, v1
    v_lshl_add_u32 v3, v4, 4, v3
    s_mul_i32 s70, s76, 1026
    s_lshl_b32 s71, s77, 5
    s_add_u32 s70, s70, s71
    s_cmp_eq_u32 s68, 2
    s_cbranch_scc1 L_a_w2
    s_cmp_eq_u32 s68, 3
    s_cbranch_scc1 L_a_w3
    s_mov_b32 m0, 32768
    s_add_u32 s72, s70, 0
    buffer_load_dwordx4 v3, s[36:39], s72 offen  lds
    s_mov_b32 m0, 33792
    s_add_u32 s72, s70, 262656
    buffer_load_dwordx4 v3, s[36:39], s72 offen  lds
    s_mov_b32 m0, 34816
    s_add_u32 s72, s70, 525312
    buffer_load_dwordx4 v3, s[36:39], s72 offen  lds
    s_mov_b32 m0, 35840
    s_add_u32 s72, s70, 787968
    buffer_load_dwordx4 v3, s[36:39], s72 offen  lds
    s_mov_b32 m0, 36864
    s_add_u32 s72, s70, 1050624
    buffer_load_dwordx4 v3, s[36:39], s72 offen  lds
    s_mov_b32 m0, 37888
    s_add_u32 s72, s70, 1313280
    buffer_load_dwordx4 v3, s[36:39], s72 offen  lds
    s_branch L_a_wdone
L_a_w2:
    s_mov_b32 m0, 38912
    s_add_u32 s72, s70, 1575936
    buffer_load_dwordx4 v3, s[36:39], s72 offen  lds
    s_mov_b32 m0, 39936
    s_add_u32 s72, s70, 1838592
    buffer_load_dwordx4 v3, s[36:39], s72 offen  lds
    s_mov_b32 m0, 40960
    s_add_u32 s72, s70, 0
    buffer_load_dwordx4 v3, s[40:43], s72 offen  lds
    s_mov_b32 m0, 41984
    s_add_u32 s72, s70, 262656
    buffer_load_dwordx4 v3, s[40:43], s72 offen  lds
    s_mov_b32 m0, 43008
    s_add_u32 s72, s70, 525312
    buffer_load_dwordx4 v3, s[40:43], s72 offen  lds
    s_branch L_a_wdone
L_a_w3:
    s_mov_b32 m0, 44032
    s_add_u32 s72, s70, 787968
    buffer_load_dwordx4 v3, s[40:43], s72 offen  lds
    s_mov_b32 m0, 45056
    s_add_u32 s72, s70, 1050624
    buffer_load_dwordx4 v3, s[40:43], s72 offen  lds
    s_mov_b32 m0, 46080
    s_add_u32 s72, s70, 1313280
    buffer_load_dwordx4 v3, s[40:43], s72 offen  lds
    s_mov_b32 m0, 47104
    s_add_u32 s72, s70, 1575936
    buffer_load_dwordx4 v3, s[40:43], s72 offen  lds
    s_mov_b32 m0, 48128
    s_add_u32 s72, s70, 1838592
    buffer_load_dwordx4 v3, s[40:43], s72 offen  lds
    s_nop 0
L_a_wdone:
    s_cmp_lg_u32 s68, 0
    s_cbranch_scc1 L_wait_skip_a1
    s_and_b32 s70, s2, 15
    s_lshl_b32 s70, s70, 10
    s_add_u32 s70, s70, 26214400
    v_lshlrev_b32 v2, 4, v1
    v_add_u32 v2, s70, v2
    s_mov_b64 s[90:91], exec
    s_sleep 4
    s_mov_b32 s92, 0
    s_nop 1
L_poll_a1:
    buffer_load_dwordx4 v[4:7], v2, s[48:51], 0 offen sc1
    s_waitcnt vmcnt(0)
    v_xor_b32 v4, s69, v4
    v_xor_b32 v5, s69, v5
    v_xor_b32 v6, s69, v6
    v_xor_b32 v7, s69, v7
    v_or_b32 v4, v4, v5
    v_or3_b32 v4, v4, v6, v7
    v_cmp_ne_u32 vcc, 0, v4
    s_add_u32 s92, s92, 1
    s_cmp_gt_u32 s92, 400000
    s_cbranch_scc1 L_poll_done_a1
    s_nop 1
    s_cmp_eq_u64 vcc, 0
    s_cbranch_scc1 L_poll_done_a1
    s_sleep 4
    s_branch L_poll_a1
L_poll_done_a1:
    s_mov_b64 exec, s[90:91]
    s_nop 1
L_wait_skip_a1:
    s_barrier
    s_xor_b32 s70, s68, 3
    s_or_b32 s70, s70, s77
    s_cmp_lg_u32 s70, 0
    s_cbranch_scc1 L_a2_nyq_ld_done
    v_lshlrev_b32 v2, 4, v1
    s_lshl_b32 s70, s76, 10
    s_add_u32 s70, s70, 4194304
    buffer_load_dwordx4 v[100:103], v2, s[48:51], s70 offen sc1
    v_lshlrev_b32 v2, 2, v8
    v_lshl_add_u32 v2, v9, 8, v2
    s_add_u32 s70, s70, 20971520
    buffer_load_dword v104, v2, s[48:51], s70 offen offset:0 sc1
    buffer_load_dword v105, v2, s[48:51], s70 offen offset:64 sc1
    buffer_load_dword v106, v2, s[48:51], s70 offen offset:128 sc1
    buffer_load_dword v107, v2, s[48:51], s70 offen offset:192 sc1
    s_nop 1
L_a2_nyq_ld_done:
    s_lshl_b32 s70, s76, 5
    s_add_u32 s70, s70, s77
    s_lshl_b32 s80, s70, 14
    s_lshl_b32 s71, s68, 12
    s_add_u32 s80, s80, s71
    s_add_u32 m0, s71, 0
    s_add_u32 s70, s80, 0
    buffer_load_dwordx4 v40, s[48:51], s70 offen sc1 lds
    s_add_u32 m0, s71, 1024
    s_add_u32 s70, s80, 1024
    buffer_load_dwordx4 v41, s[48:51], s70 offen sc1 lds
    s_add_u32 m0, s71, 2048
    s_add_u32 s70, s80, 2048
    buffer_load_dwordx4 v42, s[48:51], s70 offen sc1 lds
    s_add_u32 m0, s71, 3072
    s_add_u32 s70, s80, 3072
    buffer_load_dwordx4 v43, s[48:51], s70 offen sc1 lds
    s_waitcnt vmcnt(0)
    s_barrier
    ds_read_b32 v112, v44 offset:0
    ds_read_b32 v113, v45 offset:0
    ds_read_b32 v114, v46 offset:0
    ds_read_b32 v115, v47 offset:0
    ds_read_b32 v116, v44 offset:4
    ds_read_b32 v117, v45 offset:4
    ds_read_b32 v118, v46 offset:4
    ds_read_b32 v119, v47 offset:4
    ds_read_b32 v120, v44 offset:8
    ds_read_b32 v121, v45 offset:8
    ds_read_b32 v122, v46 offset:8
    ds_read_b32 v123, v47 offset:8
    ds_read_b32 v124, v44 offset:12
    ds_read_b32 v125, v45 offset:12
    ds_read_b32 v126, v46 offset:12
    ds_read_b32 v127, v47 offset:12
    s_waitcnt lgkmcnt(12)
    v_mfma_f32_16x16x32_bf16 v[128:131], v[112:115], v[16:19], 0
    v_mfma_f32_16x16x32_bf16 v[132:135], v[112:115], v[20:23], 0
    s_waitcnt lgkmcnt(8)
    v_mfma_f32_16x16x32_bf16 v[136:139], v[116:119], v[16:19], 0
    v_mfma_f32_16x16x32_bf16 v[140:143], v[116:119], v[20:23], 0
    s_waitcnt lgkmcnt(4)
    v_mfma_f32_16x16x32_bf16 v[144:147], v[120:123], v[16:19], 0
    v_mfma_f32_16x16x32_bf16 v[148:151], v[120:123], v[20:23], 0
    s_waitcnt lgkmcnt(0)
    v_mfma_f32_16x16x32_bf16 v[152:155], v[124:127], v[16:19], 0
    v_mfma_f32_16x16x32_bf16 v[156:159], v[124:127], v[20:23], 0
    v_mul_f32 v160, v128, v32
    v_mul_f32 v164, v132, v32
    v_mul_f32 v161, v129, v33
    v_mul_f32 v165, v133, v33
    v_mul_f32 v162, v130, v34
    v_mul_f32 v166, v134, v34
    v_mul_f32 v163, v131, v35
    v_mul_f32 v167, v135, v35
    v_fma_f32 v160, -v132, v36, v160
    v_fmac_f32 v164, v128, v36
    v_fma_f32 v161, -v133, v37, v161
    v_fmac_f32 v165, v129, v37
    v_fma_f32 v162, -v134, v38, v162
    v_fmac_f32 v166, v130, v38
    v_fma_f32 v163, -v135, v39, v163
    v_fmac_f32 v167, v131, v39
    v_cvt_pk_bf16_f32 v112, v160, v164
    v_cvt_pk_bf16_f32 v113, v161, v165
    v_cvt_pk_bf16_f32 v114, v162, v166
    v_cvt_pk_bf16_f32 v115, v163, v167
    v_mul_f32 v168, v136, v32
    v_mul_f32 v172, v140, v32
    v_mul_f32 v169, v137, v33
    v_mul_f32 v173, v141, v33
    v_mul_f32 v170, v138, v34
    v_mul_f32 v174, v142, v34
    v_mul_f32 v171, v139, v35
    v_mul_f32 v175, v143, v35
    v_fma_f32 v168, -v140, v36, v168
    v_fmac_f32 v172, v136, v36
    v_fma_f32 v169, -v141, v37, v169
    v_fmac_f32 v173, v137, v37
    v_fma_f32 v170, -v142, v38, v170
    v_fmac_f32 v174, v138, v38
    v_fma_f32 v171, -v143, v39, v171
    v_fmac_f32 v175, v139, v39
    v_cvt_pk_bf16_f32 v116, v168, v172
    v_cvt_pk_bf16_f32 v117, v169, v173
    v_cvt_pk_bf16_f32 v118, v170, v174
    v_cvt_pk_bf16_f32 v119, v171, v175
    v_mul_f32 v176, v144, v32
    v_mul_f32 v180, v148, v32
    v_mul_f32 v177, v145, v33
    v_mul_f32 v181, v149, v33
    v_mul_f32 v178, v146, v34
    v_mul_f32 v182, v150, v34
    v_mul_f32 v179, v147, v35
    v_mul_f32 v183, v151, v35
    v_fma_f32 v176, -v148, v36, v176
    v_fmac_f32 v180, v144, v36
    v_fma_f32 v177, -v149, v37, v177
    v_fmac_f32 v181, v145, v37
    v_fma_f32 v178, -v150, v38, v178
    v_fmac_f32 v182, v146, v38
    v_fma_f32 v179, -v151, v39, v179
    v_fmac_f32 v183, v147, v39
    v_cvt_pk_bf16_f32 v120, v176, v180
    v_cvt_pk_bf16_f32 v121, v177, v181
    v_cvt_pk_bf16_f32 v122, v178, v182
    v_cvt_pk_bf16_f32 v123, v179, v183
    v_mul_f32 v184, v152, v32
    v_mul_f32 v188, v156, v32
    v_mul_f32 v185, v153, v33
    v_mul_f32 v189, v157, v33
    v_mul_f32 v186, v154, v34
    v_mul_f32 v190, v158, v34
    v_mul_f32 v187, v155, v35
    v_mul_f32 v191, v159, v35
    v_fma_f32 v184, -v156, v36, v184
    v_fmac_f32 v188, v152, v36
    v_fma_f32 v185, -v157, v37, v185
    v_fmac_f32 v189, v153, v37
    v_fma_f32 v186, -v158, v38, v186
    v_fmac_f32 v190, v154, v38
    v_fma_f32 v187, -v159, v39, v187
    v_fmac_f32 v191, v155, v39
    v_cvt_pk_bf16_f32 v124, v184, v188
    v_cvt_pk_bf16_f32 v125, v185, v189
    v_cvt_pk_bf16_f32 v126, v186, v190
    v_cvt_pk_bf16_f32 v127, v187, v191
    v_mfma_f32_16x16x32_bf16 v[128:131], v[16:19], v[112:115], 0
    v_mfma_f32_16x16x32_bf16 v[132:135], v[20:23], v[112:115], 0
    v_mfma_f32_16x16x32_bf16 v[136:139], v[16:19], v[116:119], 0
    v_mfma_f32_16x16x32_bf16 v[140:143], v[20:23], v[116:119], 0
    v_mfma_f32_16x16x32_bf16 v[144:147], v[16:19], v[120:123], 0
    v_mfma_f32_16x16x32_bf16 v[148:151], v[20:23], v[120:123], 0
    v_mfma_f32_16x16x32_bf16 v[152:155], v[16:19], v[124:127], 0
    v_mfma_f32_16x16x32_bf16 v[156:159], v[20:23], v[124:127], 0
    ds_read_b64 v[52:53], v48 offset:32768
    ds_read_b64 v[54:55], v48 offset:33280
    ds_read_b64 v[56:57], v48 offset:33792
    ds_read_b64 v[58:59], v48 offset:34304
    ds_read_b64 v[60:61], v48 offset:40960
    ds_read_b64 v[62:63], v48 offset:41472
    ds_read_b64 v[64:65], v48 offset:41984
    ds_read_b64 v[66:67], v48 offset:42496
    s_mov_b32 s71, 0xffff0000
    s_waitcnt lgkmcnt(7)
    v_lshlrev_b32 v68, 16, v52
    s_waitcnt lgkmcnt(6)
    v_lshlrev_b32 v69, 16, v54
    s_waitcnt lgkmcnt(5)
    v_lshlrev_b32 v70, 16, v56
    s_waitcnt lgkmcnt(4)
    v_lshlrev_b32 v71, 16, v58
    s_waitcnt lgkmcnt(3)
    v_lshlrev_b32 v72, 16, v60
    s_waitcnt lgkmcnt(2)
    v_lshlrev_b32 v73, 16, v62
    s_waitcnt lgkmcnt(1)
    v_lshlrev_b32 v74, 16, v64
    s_waitcnt lgkmcnt(0)
    v_lshlrev_b32 v75, 16, v66
    v_and_b32 v76, s71, v52
    v_and_b32 v77, s71, v54
    v_and_b32 v78, s71, v56
    v_and_b32 v79, s71, v58
    v_and_b32 v80, s71, v60
    v_and_b32 v81, s71, v62
    v_and_b32 v82, s71, v64
    v_and_b32 v83, s71, v66
    v_lshlrev_b32 v84, 16, v53
    v_lshlrev_b32 v85, 16, v55
    v_lshlrev_b32 v86, 16, v57
    v_lshlrev_b32 v87, 16, v59
    v_lshlrev_b32 v88, 16, v61
    v_lshlrev_b32 v89, 16, v63
    v_lshlrev_b32 v90, 16, v65
    v_lshlrev_b32 v91, 16, v67
    v_and_b32 v92, s71, v53
    v_and_b32 v93, s71, v55
    v_and_b32 v94, s71, v57
    v_and_b32 v95, s71, v59
    v_and_b32 v96, s71, v61
    v_and_b32 v97, s71, v63
    v_and_b32 v98, s71, v65
    v_and_b32 v99, s71, v67
    v_mul_f32 v160, v128, v68
    v_mul_f32 v164, v132, v68
    v_mul_f32 v161, v129, v69
    v_mul_f32 v165, v133, v69
    v_mul_f32 v162, v130, v70
    v_mul_f32 v166, v134, v70
    v_mul_f32 v163, v131, v71
    v_mul_f32 v167, v135, v71
    v_fma_f32 v160, -v132, v72, v160
    v_fmac_f32 v164, v128, v72
    v_fma_f32 v161, -v133, v73, v161
    v_fmac_f32 v165, v129, v73
    v_fma_f32 v162, -v134, v74, v162
    v_fmac_f32 v166, v130, v74
    v_fma_f32 v163, -v135, v75, v163
    v_fmac_f32 v167, v131, v75
    v_cvt_pk_bf16_f32 v112, v160, v164
    v_cvt_pk_bf16_f32 v113, v161, v165
    v_cvt_pk_bf16_f32 v114, v162, v166
    v_cvt_pk_bf16_f32 v115, v163, v167
    v_mul_f32 v168, v136, v76
    v_mul_f32 v172, v140, v76
    v_mul_f32 v169, v137, v77
    v_mul_f32 v173, v141, v77
    v_mul_f32 v170, v138, v78
    v_mul_f32 v174, v142, v78
    v_mul_f32 v171, v139, v79
    v_mul_f32 v175, v143, v79
    v_fma_f32 v168, -v140, v80, v168
    v_fmac_f32 v172, v136, v80
    v_fma_f32 v169, -v141, v81, v169
    v_fmac_f32 v173, v137, v81
    v_fma_f32 v170, -v142, v82, v170
    v_fmac_f32 v174, v138, v82
    v_fma_f32 v171, -v143, v83, v171
    v_fmac_f32 v175, v139, v83
    v_cvt_pk_bf16_f32 v116, v168, v172
    v_cvt_pk_bf16_f32 v117, v169, v173
    v_cvt_pk_bf16_f32 v118, v170, v174
    v_cvt_pk_bf16_f32 v119, v171, v175
    v_mul_f32 v176, v144, v84
    v_mul_f32 v180, v148, v84
    v_mul_f32 v177, v145, v85
    v_mul_f32 v181, v149, v85
    v_mul_f32 v178, v146, v86
    v_mul_f32 v182, v150, v86
    v_mul_f32 v179, v147, v87
    v_mul_f32 v183, v151, v87
    v_fma_f32 v176, -v148, v88, v176
    v_fmac_f32 v180, v144, v88
    v_fma_f32 v177, -v149, v89, v177
    v_fmac_f32 v181, v145, v89
    v_fma_f32 v178, -v150, v90, v178
    v_fmac_f32 v182, v146, v90
    v_fma_f32 v179, -v151, v91, v179
    v_fmac_f32 v183, v147, v91
    v_cvt_pk_bf16_f32 v120, v176, v180
    v_cvt_pk_bf16_f32 v121, v177, v181
    v_cvt_pk_bf16_f32 v122, v178, v182
    v_cvt_pk_bf16_f32 v123, v179, v183
    v_mul_f32 v184, v152, v92
    v_mul_f32 v188, v156, v92
    v_mul_f32 v185, v153, v93
    v_mul_f32 v189, v157, v93
    v_mul_f32 v186, v154, v94
    v_mul_f32 v190, v158, v94
    v_mul_f32 v187, v155, v95
    v_mul_f32 v191, v159, v95
    v_fma_f32 v184, -v156, v96, v184
    v_fmac_f32 v188, v152, v96
    v_fma_f32 v185, -v157, v97, v185
    v_fmac_f32 v189, v153, v97
    v_fma_f32 v186, -v158, v98, v186
    v_fmac_f32 v190, v154, v98
    v_fma_f32 v187, -v159, v99, v187
    v_fmac_f32 v191, v155, v99
    v_cvt_pk_bf16_f32 v124, v184, v188
    v_cvt_pk_bf16_f32 v125, v185, v189
    v_cvt_pk_bf16_f32 v126, v186, v190
    v_cvt_pk_bf16_f32 v127, v187, v191
    v_mfma_f32_16x16x32_bf16 v[128:131], v[112:115], v[24:27], 0
    v_mfma_f32_16x16x32_bf16 v[132:135], v[112:115], v[28:31], 0
    v_mfma_f32_16x16x32_bf16 v[136:139], v[116:119], v[24:27], 0
    v_mfma_f32_16x16x32_bf16 v[140:143], v[116:119], v[28:31], 0
    v_mfma_f32_16x16x32_bf16 v[144:147], v[120:123], v[24:27], 0
    v_mfma_f32_16x16x32_bf16 v[148:151], v[120:123], v[28:31], 0
    v_mfma_f32_16x16x32_bf16 v[152:155], v[124:127], v[24:27], 0
    v_mfma_f32_16x16x32_bf16 v[156:159], v[124:127], v[28:31], 0
    s_nop 0
    v_mul_f32 v160, v128, v32
    v_mul_f32 v164, v132, v32
    v_mul_f32 v161, v129, v33
    v_mul_f32 v165, v133, v33
    v_mul_f32 v162, v130, v34
    v_mul_f32 v166, v134, v34
    v_mul_f32 v163, v131, v35
    v_mul_f32 v167, v135, v35
    v_fmac_f32 v160, v132, v36
    v_fma_f32 v164, -v128, v36, v164
    v_fmac_f32 v161, v133, v37
    v_fma_f32 v165, -v129, v37, v165
    v_fmac_f32 v162, v134, v38
    v_fma_f32 v166, -v130, v38, v166
    v_fmac_f32 v163, v135, v39
    v_fma_f32 v167, -v131, v39, v167
    v_cvt_pk_bf16_f32 v112, v160, v164
    v_cvt_pk_bf16_f32 v113, v161, v165
    v_cvt_pk_bf16_f32 v114, v162, v166
    v_cvt_pk_bf16_f32 v115, v163, v167
    v_mul_f32 v168, v136, v32
    v_mul_f32 v172, v140, v32
    v_mul_f32 v169, v137, v33
    v_mul_f32 v173, v141, v33
    v_mul_f32 v170, v138, v34
    v_mul_f32 v174, v142, v34
    v_mul_f32 v171, v139, v35
    v_mul_f32 v175, v143, v35
    v_fmac_f32 v168, v140, v36
    v_fma_f32 v172, -v136, v36, v172
    v_fmac_f32 v169, v141, v37
    v_fma_f32 v173, -v137, v37, v173
    v_fmac_f32 v170, v142, v38
    v_fma_f32 v174, -v138, v38, v174
    v_fmac_f32 v171, v143, v39
    v_fma_f32 v175, -v139, v39, v175
    v_cvt_pk_bf16_f32 v116, v168, v172
    v_cvt_pk_bf16_f32 v117, v169, v173
    v_cvt_pk_bf16_f32 v118, v170, v174
    v_cvt_pk_bf16_f32 v119, v171, v175
    v_mul_f32 v176, v144, v32
    v_mul_f32 v180, v148, v32
    v_mul_f32 v177, v145, v33
    v_mul_f32 v181, v149, v33
    v_mul_f32 v178, v146, v34
    v_mul_f32 v182, v150, v34
    v_mul_f32 v179, v147, v35
    v_mul_f32 v183, v151, v35
    v_fmac_f32 v176, v148, v36
    v_fma_f32 v180, -v144, v36, v180
    v_fmac_f32 v177, v149, v37
    v_fma_f32 v181, -v145, v37, v181
    v_fmac_f32 v178, v150, v38
    v_fma_f32 v182, -v146, v38, v182
    v_fmac_f32 v179, v151, v39
    v_fma_f32 v183, -v147, v39, v183
    v_cvt_pk_bf16_f32 v120, v176, v180
    v_cvt_pk_bf16_f32 v121, v177, v181
    v_cvt_pk_bf16_f32 v122, v178, v182
    v_cvt_pk_bf16_f32 v123, v179, v183
    v_mul_f32 v184, v152, v32
    v_mul_f32 v188, v156, v32
    v_mul_f32 v185, v153, v33
    v_mul_f32 v189, v157, v33
    v_mul_f32 v186, v154, v34
    v_mul_f32 v190, v158, v34
    v_mul_f32 v187, v155, v35
    v_mul_f32 v191, v159, v35
    v_fmac_f32 v184, v156, v36
    v_fma_f32 v188, -v152, v36, v188
    v_fmac_f32 v185, v157, v37
    v_fma_f32 v189, -v153, v37, v189
    v_fmac_f32 v186, v158, v38
    v_fma_f32 v190, -v154, v38, v190
    v_fmac_f32 v187, v159, v39
    v_fma_f32 v191, -v155, v39, v191
    v_cvt_pk_bf16_f32 v124, v184, v188
    v_cvt_pk_bf16_f32 v125, v185, v189
    v_cvt_pk_bf16_f32 v126, v186, v190
    v_cvt_pk_bf16_f32 v127, v187, v191
    v_mfma_f32_16x16x32_bf16 v[128:131], v[24:27], v[112:115], 0
    v_mfma_f32_16x16x32_bf16 v[132:135], v[28:31], v[112:115], 0
    v_mfma_f32_16x16x32_bf16 v[136:139], v[24:27], v[116:119], 0
    v_mfma_f32_16x16x32_bf16 v[140:143], v[28:31], v[116:119], 0
    v_mfma_f32_16x16x32_bf16 v[144:147], v[24:27], v[120:123], 0
    v_mfma_f32_16x16x32_bf16 v[148:151], v[28:31], v[120:123], 0
    v_mfma_f32_16x16x32_bf16 v[152:155], v[24:27], v[124:127], 0
    v_mfma_f32_16x16x32_bf16 v[156:159], v[28:31], v[124:127], 0
    s_nop 1
    v_cvt_pk_bf16_f32 v192, v128, v132
    v_cvt_pk_bf16_f32 v196, v129, v133
    v_cvt_pk_bf16_f32 v200, v130, v134
    v_cvt_pk_bf16_f32 v204, v131, v135
    v_cvt_pk_bf16_f32 v193, v136, v140
    v_cvt_pk_bf16_f32 v197, v137, v141
    v_cvt_pk_bf16_f32 v201, v138, v142
    v_cvt_pk_bf16_f32 v205, v139, v143
    v_cvt_pk_bf16_f32 v194, v144, v148
    v_cvt_pk_bf16_f32 v198, v145, v149
    v_cvt_pk_bf16_f32 v202, v146, v150
    v_cvt_pk_bf16_f32 v206, v147, v151
    v_cvt_pk_bf16_f32 v195, v152, v156
    v_cvt_pk_bf16_f32 v199, v153, v157
    v_cvt_pk_bf16_f32 v203, v154, v158
    v_cvt_pk_bf16_f32 v207, v155, v159
    ds_write_b128 v44, v[192:195] offset:16384
    ds_write_b128 v45, v[196:199] offset:16384
    ds_write_b128 v46, v[200:203] offset:16384
    ds_write_b128 v47, v[204:207] offset:16384
    s_xor_b32 s70, s68, 3
    s_or_b32 s70, s70, s77
    s_cmp_lg_u32 s70, 0
    s_cbranch_scc1 L_a2_nyq_done
    v_and_b32 v108, 0xffff0000, v104
    v_lshlrev_b32 v104, 16, v104
    v_and_b32 v109, 0xffff0000, v105
    v_lshlrev_b32 v105, 16, v105
    v_and_b32 v110, 0xffff0000, v106
    v_lshlrev_b32 v106, 16, v106
    v_and_b32 v111, 0xffff0000, v107
    v_lshlrev_b32 v107, 16, v107
    v_mfma_f32_16x16x32_bf16 v[128:131], v[100:103], v[16:19], 0
    v_mfma_f32_16x16x32_bf16 v[132:135], v[100:103], v[20:23], 0
    s_nop 6
    v_mul_f32 v160, v128, v32
    v_mul_f32 v164, v132, v32
    v_mul_f32 v161, v129, v33
    v_mul_f32 v165, v133, v33
    v_mul_f32 v162, v130, v34
    v_mul_f32 v166, v134, v34
    v_mul_f32 v163, v131, v35
    v_mul_f32 v167, v135, v35
    v_fma_f32 v160, -v132, v36, v160
    v_fmac_f32 v164, v128, v36
    v_fma_f32 v161, -v133, v37, v161
    v_fmac_f32 v165, v129, v37
    v_fma_f32 v162, -v134, v38, v162
    v_fmac_f32 v166, v130, v38
    v_fma_f32 v163, -v135, v39, v163
    v_fmac_f32 v167, v131, v39
    v_cvt_pk_bf16_f32 v100, v160, v164
    v_cvt_pk_bf16_f32 v101, v161, v165
    v_cvt_pk_bf16_f32 v102, v162, v166
    v_cvt_pk_bf16_f32 v103, v163, v167
    s_nop 1
    v_mfma_f32_16x16x32_bf16 v[128:131], v[16:19], v[100:103], 0
    v_mfma_f32_16x16x32_bf16 v[132:135], v[20:23], v[100:103], 0
    s_nop 6
    v_mul_f32 v160, v128, v104
    v_mul_f32 v164, v132, v104
    v_mul_f32 v161, v129, v105
    v_mul_f32 v165, v133, v105
    v_mul_f32 v162, v130, v106
    v_mul_f32 v166, v134, v106
    v_mul_f32 v163, v131, v107
    v_mul_f32 v167, v135, v107
    v_fma_f32 v160, -v132, v108, v160
    v_fmac_f32 v164, v128, v108
    v_fma_f32 v161, -v133, v109, v161
    v_fmac_f32 v165, v129, v109
    v_fma_f32 v162, -v134, v110, v162
    v_fmac_f32 v166, v130, v110
    v_fma_f32 v163, -v135, v111, v163
    v_fmac_f32 v167, v131, v111
    v_cvt_pk_bf16_f32 v100, v160, v164
    v_cvt_pk_bf16_f32 v101, v161, v165
    v_cvt_pk_bf16_f32 v102, v162, v166
    v_cvt_pk_bf16_f32 v103, v163, v167
    s_nop 1
    v_mfma_f32_16x16x32_bf16 v[128:131], v[100:103], v[24:27], 0
    v_mfma_f32_16x16x32_bf16 v[132:135], v[100:103], v[28:31], 0
    s_nop 6
    v_mul_f32 v160, v128, v32
    v_mul_f32 v164, v132, v32
    v_mul_f32 v161, v129, v33
    v_mul_f32 v165, v133, v33
    v_mul_f32 v162, v130, v34
    v_mul_f32 v166, v134, v34
    v_mul_f32 v163, v131, v35
    v_mul_f32 v167, v135, v35
    v_fmac_f32 v160, v132, v36
    v_fma_f32 v164, -v128, v36, v164
    v_fmac_f32 v161, v133, v37
    v_fma_f32 v165, -v129, v37, v165
    v_fmac_f32 v162, v134, v38
    v_fma_f32 v166, -v130, v38, v166
    v_fmac_f32 v163, v135, v39
    v_fma_f32 v167, -v131, v39, v167
    v_cvt_pk_bf16_f32 v100, v160, v164
    v_cvt_pk_bf16_f32 v101, v161, v165
    v_cvt_pk_bf16_f32 v102, v162, v166
    v_cvt_pk_bf16_f32 v103, v163, v167
    s_nop 1
    v_mfma_f32_16x16x32_bf16 v[128:131], v[24:27], v[100:103], 0
    v_mfma_f32_16x16x32_bf16 v[132:135], v[28:31], v[100:103], 0
    s_nop 7
    v_cvt_pk_bf16_f32 v100, v128, v132
    v_cvt_pk_bf16_f32 v101, v129, v133
    v_cvt_pk_bf16_f32 v102, v130, v134
    v_cvt_pk_bf16_f32 v103, v131, v135
    v_lshl_add_u32 v2, v9, 6, v8
    s_mov_b32 s70, 16896
    v_mul_lo_u32 v2, v2, s70
    s_mul_i32 s70, s76, 2112
    s_add_u32 s70, s70, 5244928
    buffer_store_dword v100, v2, s[48:51], s70 offen sc1
    s_add_u32 s70, s70, 270336
    buffer_store_dword v101, v2, s[48:51], s70 offen sc1
    s_add_u32 s70, s70, 270336
    buffer_store_dword v102, v2, s[48:51], s70 offen sc1
    s_add_u32 s70, s70, 270336
    buffer_store_dword v103, v2, s[48:51], s70 offen sc1
    s_nop 1
L_a2_nyq_done:
    s_waitcnt lgkmcnt(0)
    s_barrier
    v_bfe_u32 v2, v1, 2, 2
    v_lshl_add_u32 v2, v2, 4, v9
    s_mov_b32 s70, 16896
    v_mul_lo_u32 v2, v2, s70
    v_and_b32 v3, 3, v1
    v_lshl_add_u32 v2, v3, 4, v2
    s_mul_i32 s70, s68, 1081344
    s_mul_i32 s71, s76, 2112
    s_add_u32 s70, s70, s71
    s_lshl_b32 s71, s77, 6
    s_add_u32 s70, s70, s71
    s_add_u32 s70, s70, 5242880
    s_lshl_b32 s71, s68, 12
    v_add_u32 v4, s71, v40
    v_add_u32 v5, s71, v41
    v_add_u32 v6, s71, v42
    v_add_u32 v7, s71, v43
    ds_read_b128 v[192:195], v4 offset:16384
    ds_read_b128 v[196:199], v5 offset:17408
    ds_read_b128 v[200:203], v6 offset:18432
    ds_read_b128 v[204:207], v7 offset:19456
    s_waitcnt lgkmcnt(3)
    buffer_store_dwordx4 v[192:195], v2, s[48:51], s70 offen sc1
    s_add_u32 s70, s70, 67584
    s_waitcnt lgkmcnt(2)
    buffer_store_dwordx4 v[196:199], v2, s[48:51], s70 offen sc1
    s_add_u32 s70, s70, 67584
    s_waitcnt lgkmcnt(1)
    buffer_store_dwordx4 v[200:203], v2, s[48:51], s70 offen sc1
    s_add_u32 s70, s70, 67584
    s_waitcnt lgkmcnt(0)
    buffer_store_dwordx4 v[204:207], v2, s[48:51], s70 offen sc1
    s_waitcnt vmcnt(0)
    s_barrier
    s_cmp_lg_u32 s68, 0
    s_cbranch_scc1 L_sig_skip_a2
    s_lshl_b32 s70, s2, 2
    s_add_u32 s70, s70, 26738688
    v_lshlrev_b32 v12, 10, v1
    v_add_u32 v12, s70, v12
    v_mov_b32 v13, s69
    s_mov_b64 s[90:91], exec
    s_mov_b64 exec, 0xffff
    buffer_store_dword v13, v12, s[48:51], 0 offen sc1
    s_mov_b64 exec, s[90:91]
    s_nop 1
L_sig_skip_a2:
    v_and_b32 v8, 31, v1
    v_lshrrev_b32 v9, 5, v1
    v_lshlrev_b32 v10, 2, v9
    v_mul_u32_u24 v10, v10, v8
    v_and_b32 v11, 1, v8
    v_mul_u32_u24 v11, 0x8000, v11
    v_lshl_or_b32 v11, v11, 16, v11
    v_mad_u32_u24 v2, v8, 0, v10
    v_and_b32 v2, 31, v2
    v_cvt_f32_u32 v3, v2
    v_mul_f32 v3, 0x3d000000, v3
    v_cos_f32 v4, v3
    v_sin_f32 v5, v3
    s_nop 0
    v_cvt_pk_bf16_f32 v16, v4, -v5
    v_cvt_pk_bf16_f32 v32, v5, v4
    v_mad_u32_u24 v2, v8, 1, v10
    v_and_b32 v2, 31, v2
    v_cvt_f32_u32 v3, v2
    v_mul_f32 v3, 0x3d000000, v3
    v_cos_f32 v4, v3
    v_sin_f32 v5, v3
    s_nop 0
    v_cvt_pk_bf16_f32 v17, v4, -v5
    v_cvt_pk_bf16_f32 v33, v5, v4
    v_mad_u32_u24 v2, v8, 2, v10
    v_and_b32 v2, 31, v2
    v_cvt_f32_u32 v3, v2
    v_mul_f32 v3, 0x3d000000, v3
    v_cos_f32 v4, v3
    v_sin_f32 v5, v3
    s_nop 0
    v_cvt_pk_bf16_f32 v18, v4, -v5
    v_cvt_pk_bf16_f32 v34, v5, v4
    v_mad_u32_u24 v2, v8, 3, v10
    v_and_b32 v2, 31, v2
    v_cvt_f32_u32 v3, v2
    v_mul_f32 v3, 0x3d000000, v3
    v_cos_f32 v4, v3
    v_sin_f32 v5, v3
    s_nop 0
    v_cvt_pk_bf16_f32 v19, v4, -v5
    v_cvt_pk_bf16_f32 v35, v5, v4
    v_mad_u32_u24 v2, v8, 8, v10
    v_and_b32 v2, 31, v2
    v_cvt_f32_u32 v3, v2
    v_mul_f32 v3, 0x3d000000, v3
    v_cos_f32 v4, v3
    v_sin_f32 v5, v3
    s_nop 0
    v_cvt_pk_bf16_f32 v20, v4, -v5
    v_cvt_pk_bf16_f32 v36, v5, v4
    v_mad_u32_u24 v2, v8, 9, v10
    v_and_b32 v2, 31, v2
    v_cvt_f32_u32 v3, v2
    v_mul_f32 v3, 0x3d000000, v3
    v_cos_f32 v4, v3
    v_sin_f32 v5, v3
    s_nop 0
    v_cvt_pk_bf16_f32 v21, v4, -v5
    v_cvt_pk_bf16_f32 v37, v5, v4
    v_mad_u32_u24 v2, v8, 10, v10
    v_and_b32 v2, 31, v2
    v_cvt_f32_u32 v3, v2
    v_mul_f32 v3, 0x3d000000, v3
    v_cos_f32 v4, v3
    v_sin_f32 v5, v3
    s_nop 0
    v_cvt_pk_bf16_f32 v22, v4, -v5
    v_cvt_pk_bf16_f32 v38, v5, v4
    v_mad_u32_u24 v2, v8, 11, v10
    v_and_b32 v2, 31, v2
    v_cvt_f32_u32 v3, v2
    v_mul_f32 v3, 0x3d000000, v3
    v_cos_f32 v4, v3
    v_sin_f32 v5, v3
    s_nop 0
    v_cvt_pk_bf16_f32 v23, v4, -v5
    v_cvt_pk_bf16_f32 v39, v5, v4
    v_xor_b32 v24, v11, v16
    v_xor_b32 v40, v11, v32
    v_xor_b32 v25, v11, v17
    v_xor_b32 v41, v11, v33
    v_xor_b32 v26, v11, v18
    v_xor_b32 v42, v11, v34
    v_xor_b32 v27, v11, v19
    v_xor_b32 v43, v11, v35
    v_xor_b32 v28, v11, v20
    v_xor_b32 v44, v11, v36
    v_xor_b32 v29, v11, v21
    v_xor_b32 v45, v11, v37
    v_xor_b32 v30, v11, v22
    v_xor_b32 v46, v11, v38
    v_xor_b32 v31, v11, v23
    v_xor_b32 v47, v11, v39
    v_mad_u32_u24 v2, v8, 0, v10
    v_cvt_f32_u32 v2, v2
    v_mul_f32 v2, 0xba800000, v2
    v_cos_f32 v48, v2
    v_sin_f32 v64, v2
    v_mad_u32_u24 v2, v8, 1, v10
    v_cvt_f32_u32 v2, v2
    v_mul_f32 v2, 0xba800000, v2
    v_cos_f32 v49, v2
    v_sin_f32 v65, v2
    v_mad_u32_u24 v2, v8, 2, v10
    v_cvt_f32_u32 v2, v2
    v_mul_f32 v2, 0xba800000, v2
    v_cos_f32 v50, v2
    v_sin_f32 v66, v2
    v_mad_u32_u24 v2, v8, 3, v10
    v_cvt_f32_u32 v2, v2
    v_mul_f32 v2, 0xba800000, v2
    v_cos_f32 v51, v2
    v_sin_f32 v67, v2
    v_mad_u32_u24 v2, v8, 8, v10
    v_cvt_f32_u32 v2, v2
    v_mul_f32 v2, 0xba800000, v2
    v_cos_f32 v52, v2
    v_sin_f32 v68, v2
    v_mad_u32_u24 v2, v8, 9, v10
    v_cvt_f32_u32 v2, v2
    v_mul_f32 v2, 0xba800000, v2
    v_cos_f32 v53, v2
    v_sin_f32 v69, v2
    v_mad_u32_u24 v2, v8, 10, v10
    v_cvt_f32_u32 v2, v2
    v_mul_f32 v2, 0xba800000, v2
    v_cos_f32 v54, v2
    v_sin_f32 v70, v2
    v_mad_u32_u24 v2, v8, 11, v10
    v_cvt_f32_u32 v2, v2
    v_mul_f32 v2, 0xba800000, v2
    v_cos_f32 v55, v2
    v_sin_f32 v71, v2
    v_mad_u32_u24 v2, v8, 16, v10
    v_cvt_f32_u32 v2, v2
    v_mul_f32 v2, 0xba800000, v2
    v_cos_f32 v56, v2
    v_sin_f32 v72, v2
    v_mad_u32_u24 v2, v8, 17, v10
    v_cvt_f32_u32 v2, v2
    v_mul_f32 v2, 0xba800000, v2
    v_cos_f32 v57, v2
    v_sin_f32 v73, v2
    v_mad_u32_u24 v2, v8, 18, v10
    v_cvt_f32_u32 v2, v2
    v_mul_f32 v2, 0xba800000, v2
    v_cos_f32 v58, v2
    v_sin_f32 v74, v2
    v_mad_u32_u24 v2, v8, 19, v10
    v_cvt_f32_u32 v2, v2
    v_mul_f32 v2, 0xba800000, v2
    v_cos_f32 v59, v2
    v_sin_f32 v75, v2
    v_mad_u32_u24 v2, v8, 24, v10
    v_cvt_f32_u32 v2, v2
    v_mul_f32 v2, 0xba800000, v2
    v_cos_f32 v60, v2
    v_sin_f32 v76, v2
    v_mad_u32_u24 v2, v8, 25, v10
    v_cvt_f32_u32 v2, v2
    v_mul_f32 v2, 0xba800000, v2
    v_cos_f32 v61, v2
    v_sin_f32 v77, v2
    v_mad_u32_u24 v2, v8, 26, v10
    v_cvt_f32_u32 v2, v2
    v_mul_f32 v2, 0xba800000, v2
    v_cos_f32 v62, v2
    v_sin_f32 v78, v2
    v_mad_u32_u24 v2, v8, 27, v10
    v_cvt_f32_u32 v2, v2
    v_mul_f32 v2, 0xba800000, v2
    v_cos_f32 v63, v2
    v_sin_f32 v79, v2
    v_bfe_u32 v12, v1, 3, 1
    v_lshrrev_b32 v13, 5, v1
    v_cmp_eq_u32 vcc, v12, v13
    v_mov_b32 v14, 0x35000000
    s_nop 0
    v_cndmask_b32 v2, 0, v14, vcc
    v_lshlrev_b32 v3, 29, v1
    v_and_b32 v3, 0x80000000, v3
    v_xor_b32 v4, v3, v2
    v_and_b32 v5, 3, v1
    v_lshlrev_b32 v5, 8, v5
    v_add_u32 v5, s2, v5
    v_bfe_u32 v6, v1, 4, 1
    v_lshlrev_b32 v6, 2, v6
    v_add_u32 v7, 0, v6
    v_mul_u32_u24 v7, v5, v7
    v_and_b32 v7, 0x7ff, v7
    v_cvt_f32_u32 v14, v7
    v_mul_f32 v14, 0x3a000000, v14
    v_cos_f32 v12, v14
    v_sin_f32 v13, v14
    s_nop 0
    v_xor_b32 v13, v3, v13
    v_sub_f32 v14, v12, v13
    v_add_f32 v15, v12, v13
    v_mul_f32 v88, v2, v14
    v_mul_f32 v89, v4, v15
    v_mul_f32 v90, v2, v15
    v_mul_f32 v91, v4, v14
    v_cvt_pk_bf16_f32 v80, v88, -v89
    v_cvt_pk_bf16_f32 v84, v90, v91
    v_add_u32 v7, 1, v6
    v_mul_u32_u24 v7, v5, v7
    v_and_b32 v7, 0x7ff, v7
    v_cvt_f32_u32 v14, v7
    v_mul_f32 v14, 0x3a000000, v14
    v_cos_f32 v12, v14
    v_sin_f32 v13, v14
    s_nop 0
    v_xor_b32 v13, v3, v13
    v_add_f32 v14, v12, v13
    v_sub_f32 v15, v13, v12
    v_mul_f32 v88, v2, v14
    v_mul_f32 v89, v4, v15
    v_mul_f32 v90, v2, v15
    v_mul_f32 v91, v4, v14
    v_cvt_pk_bf16_f32 v81, v88, -v89
    v_cvt_pk_bf16_f32 v85, v90, v91
    v_add_u32 v7, 2, v6
    v_mul_u32_u24 v7, v5, v7
    v_and_b32 v7, 0x7ff, v7
    v_cvt_f32_u32 v14, v7
    v_mul_f32 v14, 0x3a000000, v14
    v_cos_f32 v12, v14
    v_sin_f32 v13, v14
    s_nop 0
    v_xor_b32 v13, v3, v13
    v_sub_f32 v14, v12, v13
    v_add_f32 v15, v12, v13
    v_mul_f32 v88, v2, v14
    v_mul_f32 v89, v4, v15
    v_mul_f32 v90, v2, v15
    v_mul_f32 v91, v4, v14
    v_cvt_pk_bf16_f32 v82, v88, -v89
    v_cvt_pk_bf16_f32 v86, v90, v91
    v_add_u32 v7, 3, v6
    v_mul_u32_u24 v7, v5, v7
    v_and_b32 v7, 0x7ff, v7
    v_cvt_f32_u32 v14, v7
    v_mul_f32 v14, 0x3a000000, v14
    v_cos_f32 v12, v14
    v_sin_f32 v13, v14
    s_nop 0
    v_xor_b32 v13, v3, v13
    v_add_f32 v14, v12, v13
    v_sub_f32 v15, v13, v12
    v_mul_f32 v88, v2, v14
    v_mul_f32 v89, v4, v15
    v_mul_f32 v90, v2, v15
    v_mul_f32 v91, v4, v14
    v_cvt_pk_bf16_f32 v83, v88, -v89
    v_cvt_pk_bf16_f32 v87, v90, v91
    v_bfe_u32 v4, v1, 4, 1
    v_mul_u32_u24 v2, 8448, v4
    v_lshrrev_b32 v4, 5, v1
    v_lshl_add_u32 v2, v4, 6, v2
    v_and_b32 v4, 15, v1
    v_lshl_add_u32 v2, v4, 2, v2
    s_lshl_b32 s70, s68, 7
    v_add_u32 v2, s70, v2
    v_and_b32 v4, 7, v1
    v_mul_u32_u24 v3, 2112, v4
    v_bfe_u32 v4, v1, 3, 1
    v_lshl_add_u32 v3, v4, 6, v3
    v_lshrrev_b32 v4, 4, v1
    v_lshl_add_u32 v3, v4, 4, v3
    v_add_u32 v3, s70, v3
    v_lshlrev_b32 v4, 4, v1
    s_cmp_lg_u32 s68, 0
    s_cbranch_scc1 L_wait_skip_a2
    s_and_b32 s70, s2, 15
    s_lshl_b32 s70, s70, 10
    s_add_u32 s70, s70, 26738688
    v_lshlrev_b32 v88, 4, v1
    v_add_u32 v88, s70, v88
    s_mov_b64 s[90:91], exec
    s_sleep 4
    s_mov_b32 s92, 0
    s_nop 1
L_poll_a2:
    buffer_load_dwordx4 v[90:93], v88, s[48:51], 0 offen sc1
    s_waitcnt vmcnt(0)
    v_xor_b32 v90, s69, v90
    v_xor_b32 v91, s69, v91
    v_xor_b32 v92, s69, v92
    v_xor_b32 v93, s69, v93
    v_or_b32 v90, v90, v91
    v_or3_b32 v90, v90, v92, v93
    v_cmp_ne_u32 vcc, 0, v90
    s_add_u32 s92, s92, 1
    s_cmp_gt_u32 s92, 400000
    s_cbranch_scc1 L_poll_done_a2
    s_nop 1
    s_cmp_eq_u64 vcc, 0
    s_cbranch_scc1 L_poll_done_a2
    s_sleep 4
    s_branch L_poll_a2
L_poll_done_a2:
    s_mov_b64 exec, s[90:91]
    s_nop 1
L_wait_skip_a2:
    s_barrier
    s_mul_i32 s80, s2, 16896
    s_add_u32 s80, s80, 5242880
    s_lshl_b32 s71, s68, 12
    s_add_u32 s72, s80, s71
    s_add_u32 m0, s71, 0
    s_add_u32 s70, s72, 0
    buffer_load_dwordx4 v4, s[48:51], s70 offen sc1 lds
    s_add_u32 m0, s71, 1024
    s_add_u32 s70, s72, 1024
    buffer_load_dwordx4 v4, s[48:51], s70 offen sc1 lds
    s_add_u32 m0, s71, 2048
    s_add_u32 s70, s72, 2048
    buffer_load_dwordx4 v4, s[48:51], s70 offen sc1 lds
    s_add_u32 m0, s71, 3072
    s_add_u32 s70, s72, 3072
    buffer_load_dwordx4 v4, s[48:51], s70 offen sc1 lds
    s_cmp_lg_u32 s68, 0
    s_cbranch_scc1 L_a3_ld_done
    s_mov_b32 m0, 16384
    s_add_u32 s70, s80, 16384
    buffer_load_dwordx4 v4, s[48:51], s70 offen sc1 lds
    s_nop 0
L_a3_ld_done:
    s_waitcnt vmcnt(0)
    s_barrier
    ds_read_b32 v96, v2 offset:0
    ds_read_b32 v97, v2 offset:2112
    ds_read_b32 v98, v2 offset:4224
    ds_read_b32 v99, v2 offset:6336
    ds_read_b32 v100, v2 offset:512
    ds_read_b32 v101, v2 offset:2624
    ds_read_b32 v102, v2 offset:4736
    ds_read_b32 v103, v2 offset:6848
    ds_read_b32 v104, v2 offset:1024
    ds_read_b32 v105, v2 offset:3136
    ds_read_b32 v106, v2 offset:5248
    ds_read_b32 v107, v2 offset:7360
    ds_read_b32 v108, v2 offset:1536
    ds_read_b32 v109, v2 offset:3648
    ds_read_b32 v110, v2 offset:5760
    ds_read_b32 v111, v2 offset:7872
    ds_read_b32 v112, v2 offset:2048
    ds_read_b32 v113, v2 offset:4160
    ds_read_b32 v114, v2 offset:6272
    ds_read_b32 v115, v2 offset:8384
    s_waitcnt lgkmcnt(14)
    v_mfma_f32_16x16x32_bf16 v[116:119], v[96:99], v[80:83], 0
    v_mfma_f32_16x16x32_bf16 v[120:123], v[96:99], v[84:87], 0
    s_waitcnt lgkmcnt(12)
    v_mfma_f32_16x16x32_bf16 v[124:127], v[100:103], v[80:83], 0
    v_mfma_f32_16x16x32_bf16 v[128:131], v[100:103], v[84:87], 0
    s_waitcnt lgkmcnt(8)
    v_mfma_f32_16x16x32_bf16 v[132:135], v[104:107], v[80:83], 0
    v_mfma_f32_16x16x32_bf16 v[136:139], v[104:107], v[84:87], 0
    s_waitcnt lgkmcnt(4)
    v_mfma_f32_16x16x32_bf16 v[140:143], v[108:111], v[80:83], 0
    v_mfma_f32_16x16x32_bf16 v[144:147], v[108:111], v[84:87], 0
    s_waitcnt lgkmcnt(0)
    v_mfma_f32_16x16x32_bf16 v[148:151], v[112:115], v[80:83], 0
    v_mfma_f32_16x16x32_bf16 v[152:155], v[112:115], v[84:87], 0
    v_cvt_pk_bf16_f32 v156, v116, v120
    v_cvt_pk_bf16_f32 v157, v117, v121
    v_cvt_pk_bf16_f32 v158, v118, v122
    v_cvt_pk_bf16_f32 v159, v119, v123
    ds_write_b128 v3, v[156:159] offset:17408
    v_cvt_pk_bf16_f32 v160, v124, v128
    v_cvt_pk_bf16_f32 v161, v125, v129
    v_cvt_pk_bf16_f32 v162, v126, v130
    v_cvt_pk_bf16_f32 v163, v127, v131
    ds_write_b128 v3, v[160:163] offset:17920
    v_cvt_pk_bf16_f32 v164, v132, v136
    v_cvt_pk_bf16_f32 v165, v133, v137
    v_cvt_pk_bf16_f32 v166, v134, v138
    v_cvt_pk_bf16_f32 v167, v135, v139
    ds_write_b128 v3, v[164:167] offset:18432
    v_cvt_pk_bf16_f32 v168, v140, v144
    v_cvt_pk_bf16_f32 v169, v141, v145
    v_cvt_pk_bf16_f32 v170, v142, v146
    v_cvt_pk_bf16_f32 v171, v143, v147
    ds_write_b128 v3, v[168:171] offset:18944
    v_cvt_pk_bf16_f32 v172, v148, v152
    v_cvt_pk_bf16_f32 v173, v149, v153
    v_cvt_pk_bf16_f32 v174, v150, v154
    v_cvt_pk_bf16_f32 v175, v151, v155
    s_cmp_lg_u32 s68, 0
    s_cbranch_scc1 L_a3_nyq_done
    s_mov_b64 exec, 0xff
    ds_write_b128 v3, v[172:175] offset:19456
    s_mov_b64 exec, -1
    s_nop 1
L_a3_nyq_done:
    s_waitcnt lgkmcnt(0)
    s_barrier
    v_lshlrev_b32 v4, 2, v8
    v_lshl_add_u32 v4, v9, 9, v4
    s_mul_i32 s70, s68, 2112
    v_add_u32 v5, s70, v4
    s_add_u32 s71, s70, 9088
    v_sub_u32 v6, s71, v4
    ds_read_b32 v96, v5 offset:17408
    ds_read_b32 v97, v5 offset:17536
    ds_read_b32 v98, v5 offset:17664
    ds_read_b32 v99, v5 offset:17792
    ds_read_b32 v100, v5 offset:18432
    ds_read_b32 v101, v5 offset:18560
    ds_read_b32 v102, v5 offset:18688
    ds_read_b32 v103, v5 offset:18816
    ds_read_b32 v104, v6 offset:18816
    ds_read_b32 v105, v6 offset:18688
    ds_read_b32 v106, v6 offset:18560
    ds_read_b32 v107, v6 offset:18432
    ds_read_b32 v108, v6 offset:17792
    ds_read_b32 v109, v6 offset:17664
    ds_read_b32 v110, v6 offset:17536
    ds_read_b32 v111, v6 offset:17408
    v_mov_b32 v7, s70
    ds_read_b32 v12, v7 offset:25856
    ds_read_b32 v13, v7 offset:19456
    s_mov_b32 s71, 0xffff0000
    v_cmp_eq_u32 vcc, 0, v1
    s_waitcnt lgkmcnt(14)
    v_lshlrev_b32 v14, 16, v96
    s_waitcnt lgkmcnt(1)
    v_lshlrev_b32 v15, 16, v12
    v_add_f32 v14, v14, v15
    v_mul_f32 v14, 0.5, v14
    v_and_b32 v15, s71, v96
    v_and_b32 v12, s71, v12
    v_add_f32 v15, v15, v12
    v_mul_f32 v15, 0.5, v15
    v_cvt_pk_bf16_f32 v14, v14, v15
    v_cndmask_b32 v96, v96, v14, vcc
    v_lshlrev_b32 v14, 16, v104
    s_waitcnt lgkmcnt(0)
    v_lshlrev_b32 v15, 16, v13
    v_add_f32 v14, v14, v15
    v_mul_f32 v14, 0.5, v14
    v_and_b32 v15, s71, v104
    v_and_b32 v13, s71, v13
    v_add_f32 v15, v15, v13
    v_mul_f32 v15, 0.5, v15
    v_cvt_pk_bf16_f32 v14, v14, v15
    v_cndmask_b32 v104, v104, v14, vcc
    v_mfma_f32_32x32x16_bf16 v[112:127], v[96:99], v[16:19], 0
    v_mfma_f32_32x32x16_bf16 v[128:143], v[96:99], v[32:35], 0
    v_mfma_f32_32x32x16_bf16 v[112:127], v[100:103], v[20:23], v[112:127]
    v_mfma_f32_32x32x16_bf16 v[128:143], v[100:103], v[36:39], v[128:143]
    v_mfma_f32_32x32x16_bf16 v[112:127], v[104:107], v[24:27], v[112:127]
    v_mfma_f32_32x32x16_bf16 v[128:143], v[104:107], v[40:43], v[128:143]
    v_mfma_f32_32x32x16_bf16 v[112:127], v[108:111], v[28:31], v[112:127]
    v_mfma_f32_32x32x16_bf16 v[128:143], v[108:111], v[44:47], v[128:143]
    s_nop 10
    v_mul_f32 v144, v112, v48
    v_mul_f32 v160, v128, v48
    v_mul_f32 v145, v113, v49
    v_mul_f32 v161, v129, v49
    v_mul_f32 v146, v114, v50
    v_mul_f32 v162, v130, v50
    v_mul_f32 v147, v115, v51
    v_mul_f32 v163, v131, v51
    v_mul_f32 v148, v116, v52
    v_mul_f32 v164, v132, v52
    v_mul_f32 v149, v117, v53
    v_mul_f32 v165, v133, v53
    v_mul_f32 v150, v118, v54
    v_mul_f32 v166, v134, v54
    v_mul_f32 v151, v119, v55
    v_mul_f32 v167, v135, v55
    v_mul_f32 v152, v120, v56
    v_mul_f32 v168, v136, v56
    v_mul_f32 v153, v121, v57
    v_mul_f32 v169, v137, v57
    v_mul_f32 v154, v122, v58
    v_mul_f32 v170, v138, v58
    v_mul_f32 v155, v123, v59
    v_mul_f32 v171, v139, v59
    v_mul_f32 v156, v124, v60
    v_mul_f32 v172, v140, v60
    v_mul_f32 v157, v125, v61
    v_mul_f32 v173, v141, v61
    v_mul_f32 v158, v126, v62
    v_mul_f32 v174, v142, v62
    v_mul_f32 v159, v127, v63
    v_mul_f32 v175, v143, v63
    v_fmac_f32 v144, v128, v64
    v_fma_f32 v160, -v112, v64, v160
    v_fmac_f32 v145, v129, v65
    v_fma_f32 v161, -v113, v65, v161
    v_fmac_f32 v146, v130, v66
    v_fma_f32 v162, -v114, v66, v162
    v_fmac_f32 v147, v131, v67
    v_fma_f32 v163, -v115, v67, v163
    v_fmac_f32 v148, v132, v68
    v_fma_f32 v164, -v116, v68, v164
    v_fmac_f32 v149, v133, v69
    v_fma_f32 v165, -v117, v69, v165
    v_fmac_f32 v150, v134, v70
    v_fma_f32 v166, -v118, v70, v166
    v_fmac_f32 v151, v135, v71
    v_fma_f32 v167, -v119, v71, v167
    v_fmac_f32 v152, v136, v72
    v_fma_f32 v168, -v120, v72, v168
    v_fmac_f32 v153, v137, v73
    v_fma_f32 v169, -v121, v73, v169
    v_fmac_f32 v154, v138, v74
    v_fma_f32 v170, -v122, v74, v170
    v_fmac_f32 v155, v139, v75
    v_fma_f32 v171, -v123, v75, v171
    v_fmac_f32 v156, v140, v76
    v_fma_f32 v172, -v124, v76, v172
    v_fmac_f32 v157, v141, v77
    v_fma_f32 v173, -v125, v77, v173
    v_fmac_f32 v158, v142, v78
    v_fma_f32 v174, -v126, v78, v174
    v_fmac_f32 v159, v143, v79
    v_fma_f32 v175, -v127, v79, v175
    v_cvt_pk_bf16_f32 v96, v144, v160
    v_cvt_pk_bf16_f32 v97, v145, v161
    v_cvt_pk_bf16_f32 v98, v146, v162
    v_cvt_pk_bf16_f32 v99, v147, v163
    v_cvt_pk_bf16_f32 v100, v148, v164
    v_cvt_pk_bf16_f32 v101, v149, v165
    v_cvt_pk_bf16_f32 v102, v150, v166
    v_cvt_pk_bf16_f32 v103, v151, v167
    v_cvt_pk_bf16_f32 v104, v152, v168
    v_cvt_pk_bf16_f32 v105, v153, v169
    v_cvt_pk_bf16_f32 v106, v154, v170
    v_cvt_pk_bf16_f32 v107, v155, v171
    v_cvt_pk_bf16_f32 v108, v156, v172
    v_cvt_pk_bf16_f32 v109, v157, v173
    v_cvt_pk_bf16_f32 v110, v158, v174
    v_cvt_pk_bf16_f32 v111, v159, v175
    v_mfma_f32_32x32x16_bf16 v[112:127], v[96:99], v[16:19], 0
    v_mfma_f32_32x32x16_bf16 v[128:143], v[96:99], v[32:35], 0
    v_mfma_f32_32x32x16_bf16 v[112:127], v[100:103], v[20:23], v[112:127]
    v_mfma_f32_32x32x16_bf16 v[128:143], v[100:103], v[36:39], v[128:143]
    v_mfma_f32_32x32x16_bf16 v[112:127], v[104:107], v[24:27], v[112:127]
    v_mfma_f32_32x32x16_bf16 v[128:143], v[104:107], v[40:43], v[128:143]
    v_mfma_f32_32x32x16_bf16 v[112:127], v[108:111], v[28:31], v[112:127]
    v_mfma_f32_32x32x16_bf16 v[128:143], v[108:111], v[44:47], v[128:143]
    v_lshlrev_b32 v2, 6, v8
    v_lshl_add_u32 v2, v9, 4, v2
    s_nop 8
    v_cvt_pk_bf16_f32 v144, v112, v113
    v_cvt_pk_bf16_f32 v145, v114, v115
    v_cvt_pk_bf16_f32 v146, v116, v117
    v_cvt_pk_bf16_f32 v147, v118, v119
    v_cvt_pk_bf16_f32 v148, v120, v121
    v_cvt_pk_bf16_f32 v149, v122, v123
    v_cvt_pk_bf16_f32 v150, v124, v125
    v_cvt_pk_bf16_f32 v151, v126, v127
    v_cvt_pk_bf16_f32 v152, v128, v129
    v_cvt_pk_bf16_f32 v153, v130, v131
    v_cvt_pk_bf16_f32 v154, v132, v133
    v_cvt_pk_bf16_f32 v155, v134, v135
    v_cvt_pk_bf16_f32 v156, v136, v137
    v_cvt_pk_bf16_f32 v157, v138, v139
    v_cvt_pk_bf16_f32 v158, v140, v141
    v_cvt_pk_bf16_f32 v159, v142, v143
    s_lshl_b32 s70, s68, 20
    s_lshl_b32 s71, s2, 12
    s_add_u32 s70, s70, s71
    v_permlane32_swap_b32 v144, v146
    v_permlane32_swap_b32 v145, v147
    buffer_store_dwordx4 v[144:147], v2, s[44:47], s70 offen offset:0 nt
    v_permlane32_swap_b32 v148, v150
    v_permlane32_swap_b32 v149, v151
    buffer_store_dwordx4 v[148:151], v2, s[44:47], s70 offen offset:32 nt
    s_add_u32 s70, s70, 4194304
    v_permlane32_swap_b32 v152, v154
    v_permlane32_swap_b32 v153, v155
    buffer_store_dwordx4 v[152:155], v2, s[44:47], s70 offen offset:0 nt
    v_permlane32_swap_b32 v156, v158
    v_permlane32_swap_b32 v157, v159
    buffer_store_dwordx4 v[156:159], v2, s[44:47], s70 offen offset:32 nt
    s_endpgm
L_role_b:
    s_mov_b32 s36, s12
    s_and_b32 s37, s13, 0xffff
    s_mov_b32 s38, 4194304
    s_mov_b32 s39, 0x20000
    s_mov_b32 s40, s14
    s_and_b32 s41, s15, 0xffff
    s_mov_b32 s42, 4194304
    s_mov_b32 s43, 0x20000
    s_sub_u32 s78, s2, 256
    s_and_b32 s70, s78, 7
    s_lshr_b32 s71, s78, 3
    s_and_b32 s77, s71, 15
    s_lshr_b32 s71, s71, 4
    s_lshl_b32 s76, s70, 1
    s_add_u32 s76, s76, s71
    v_bfe_u32 v2, v1, 3, 1
    v_lshlrev_b32 v2, 2, v2
    v_lshrrev_b32 v3, 4, v1
    v_add_u32 v2, v2, v3
    v_lshlrev_b32 v2, 11, v2
    v_and_b32 v3, 7, v1
    v_lshl_add_u32 v4, v3, 4, v2
    v_xor_b32 v5, 64, v4
    s_lshl_b32 s70, s77, 18
    s_lshl_b32 s71, s68, 16
    s_add_u32 s70, s70, s71
    s_lshl_b32 s71, s76, 7
    s_add_u32 s70, s70, s71
    s_mul_i32 s72, s68, 9216
    s_add_u32 s71, s70, 4294959104
    v_add_u32 v6, s71, v4
    s_add_u32 m0, s72, 0
    s_nop 0
    buffer_load_dwordx4 v6, s[36:39], 0 offen nt lds
    s_add_u32 s71, s70, 8192
    v_add_u32 v6, s71, v5
    s_add_u32 m0, s72, 1024
    s_nop 0
    buffer_load_dwordx4 v6, s[36:39], 0 offen nt lds
    s_add_u32 s71, s70, 24576
    v_add_u32 v6, s71, v4
    s_add_u32 m0, s72, 2048
    s_nop 0
    buffer_load_dwordx4 v6, s[36:39], 0 offen nt lds
    s_add_u32 s71, s70, 40960
    v_add_u32 v6, s71, v5
    s_add_u32 m0, s72, 3072
    s_nop 0
    buffer_load_dwordx4 v6, s[36:39], 0 offen nt lds
    s_add_u32 s71, s70, 57344
    v_add_u32 v6, s71, v4
    s_add_u32 m0, s72, 4096
    s_nop 0
    buffer_load_dwordx4 v6, s[36:39], 0 offen nt lds
    s_add_u32 s71, s70, 0
    s_add_u32 m0, s72, 5120
    s_nop 0
    buffer_load_dwordx4 v4, s[40:43], s71 offen nt lds
    s_add_u32 s71, s70, 16384
    s_add_u32 m0, s72, 6144
    s_nop 0
    buffer_load_dwordx4 v5, s[40:43], s71 offen nt lds
    s_add_u32 s71, s70, 32768
    s_add_u32 m0, s72, 7168
    s_nop 0
    buffer_load_dwordx4 v4, s[40:43], s71 offen nt lds
    s_add_u32 s71, s70, 49152
    s_add_u32 m0, s72, 8192
    s_nop 0
    buffer_load_dwordx4 v5, s[40:43], s71 offen nt lds
    s_mov_b32 s60, s16
    s_and_b32 s61, s17, 0xffff
    s_mov_b32 s62, 8192
    s_mov_b32 s63, 0x20000
    s_lshl_b32 s71, s76, 9
    v_lshlrev_b32 v6, 4, v1
    s_lshl_b32 s72, s68, 9
    s_add_u32 m0, s72, 70016
    s_mov_b32 exec_hi, 0
    buffer_load_dwordx4 v6, s[60:63], s71 offen lds
    s_mov_b32 exec_hi, -1
    s_mul_i32 s80, s68, 8288
    s_add_u32 s80, s80, 36864
    s_lshl_b32 s79, s76, 6
    s_lshl_b32 s71, s77, 2
    s_add_u32 s79, s79, s71
    s_add_u32 s79, s79, s68
    s_mov_b32 s56, s18
    s_and_b32 s57, s19, 0xffff
    s_mov_b32 s58, 4194304
    s_mov_b32 s59, 0x20000
    s_lshl_b32 s70, s79, 12
    s_add_u32 m0, s80, 32
    s_cmp_ge_u32 s68, 2
    s_cselect_b32 s64, s8, s6
    s_cselect_b32 s65, s9, s7
    s_and_b32 s65, s65, 0xffff
    s_mov_b32 s66, 2101248
    s_mov_b32 s67, 0x20000
    s_lshr_b32 s71, s78, 3
    s_lshl_b32 s71, s71, 1
    s_and_b32 s72, s68, 1
    s_add_u32 s71, s71, s72
    s_lshl_b32 s71, s71, 2
    v_lshrrev_b32 v7, 4, v1
    v_add_u32 v7, s71, v7
    v_lshlrev_b32 v7, 3, v7
    s_and_b32 s72, s78, 7
    v_add_u32 v7, s72, v7
    v_mul_u32_u24 v7, 1026, v7
    v_and_b32 v7, 0xffffff80, v7
    v_and_b32 v8, 15, v1
    v_min_u32 v8, 9, v8
    v_lshl_add_u32 v7, v8, 7, v7
    s_mov_b32 s32, s10
    s_and_b32 s33, s11, 0xffff
    s_mov_b32 s34, 4194304
    s_mov_b32 s35, 0x20000
    s_mov_b32 s44, s22
    s_and_b32 s45, s23, 0xffff
    s_mov_b32 s46, 8388608
    s_mov_b32 s47, 0x20000
    s_mov_b32 s48, s26
    s_and_b32 s49, s27, 0xffff
    s_mov_b32 s50, 27262976
    s_mov_b32 s51, 0x20000
    s_lshl_b32 s70, s79, 12
    s_load_dword s84, s[18:19], s70
    s_lshl_b32 s71, s79, 1
    s_and_b32 s71, s71, 0xfffffffc
    s_load_dword s88, s[20:21], s71
    v_lshrrev_b32 v2, 4, v1
    v_bfe_u32 v3, v1, 2, 2
    v_and_b32 v4, 3, v1
    v_lshrrev_b32 v5, 1, v4
    v_lshl_add_u32 v5, v2, 1, v5
    v_and_b32 v6, 1, v4
    v_lshlrev_b32 v6, 3, v6
    s_mul_i32 s72, s68, 9216
    v_add_u32 v7, 0, v3
    v_lshrrev_b32 v8, 1, v7
    v_and_b32 v9, 1, v8
    v_lshlrev_b32 v9, 2, v9
    v_xor_b32 v9, v9, v5
    v_lshl_add_u32 v21, v9, 4, v6
    v_lshl_add_u32 v21, v8, 10, v21
    v_and_b32 v7, 1, v7
    v_lshl_add_u32 v21, v7, 7, v21
    v_add_u32 v21, s72, v21
    v_add_u32 v7, 1, v3
    v_lshrrev_b32 v8, 1, v7
    v_and_b32 v9, 1, v8
    v_lshlrev_b32 v9, 2, v9
    v_xor_b32 v9, v9, v5
    v_lshl_add_u32 v22, v9, 4, v6
    v_lshl_add_u32 v22, v8, 10, v22
    v_and_b32 v7, 1, v7
    v_lshl_add_u32 v22, v7, 7, v22
    v_add_u32 v22, s72, v22
    v_lshlrev_b32 v23, 8, v3
    v_lshl_add_u32 v23, v2, 5, v23
    v_lshl_add_u32 v23, v4, 3, v23
    v_add_u32 v23, s72, v23
    v_lshlrev_b32 v24, 3, v1
    s_lshl_b32 s72, s68, 9
    s_add_u32 s72, s72, 70016
    v_add_u32 v24, s72, v24
    s_waitcnt vmcnt(0)
    s_lshl_b32 s70, s79, 12
    v_lshlrev_b32 v25, 4, v1
    s_add_u32 m0, s80, 32
    s_nop 0
    buffer_load_dwordx4 v25, s[56:59], s70 offen offset:0 nt lds
    buffer_load_dwordx4 v25, s[56:59], s70 offen offset:1024 nt lds
    buffer_load_dwordx4 v25, s[56:59], s70 offen offset:2048 nt lds
    buffer_load_dwordx4 v25, s[56:59], s70 offen offset:3072 nt lds
    s_and_b32 s70, s2, 63
    s_lshl_b32 s70, s70, 2
    v_mov_b32 v26, s70
    buffer_load_dword v37, v26, s[52:55], 0 offen sc1
    ds_read_b64 v[10:11], v24
    ds_read_b64_tr_b16 v[64:65], v22 offset:0
    ds_read_b64_tr_b16 v[66:67], v22 offset:2048
    ds_read_b64_tr_b16 v[68:69], v22 offset:256
    ds_read_b64_tr_b16 v[70:71], v22 offset:2304
    ds_read_b64_tr_b16 v[72:73], v22 offset:512
    ds_read_b64_tr_b16 v[74:75], v22 offset:2560
    ds_read_b64_tr_b16 v[76:77], v22 offset:768
    ds_read_b64_tr_b16 v[78:79], v22 offset:2816
    ds_read_b64_tr_b16 v[80:81], v23
    ds_read_b64_tr_b16 v[84:85], v21 offset:5120
    ds_read_b64_tr_b16 v[86:87], v21 offset:7168
    ds_read_b64_tr_b16 v[88:89], v21 offset:5376
    ds_read_b64_tr_b16 v[90:91], v21 offset:7424
    ds_read_b64_tr_b16 v[92:93], v21 offset:5632
    ds_read_b64_tr_b16 v[94:95], v21 offset:7680
    ds_read_b64_tr_b16 v[96:97], v21 offset:5888
    ds_read_b64_tr_b16 v[98:99], v21 offset:7936
    s_mov_b32 s81, 0xffff0000
    s_waitcnt lgkmcnt(0)
    v_lshlrev_b32 v192, 16, v10
    v_lshlrev_b32 v193, 16, v10
    v_and_b32 v194, s81, v10
    v_and_b32 v195, s81, v10
    v_lshlrev_b32 v196, 16, v11
    v_lshlrev_b32 v197, 16, v11
    v_and_b32 v198, s81, v11
    v_and_b32 v199, s81, v11
    v_lshlrev_b32 v104, 16, v64
    v_and_b32 v105, s81, v64
    v_lshlrev_b32 v106, 16, v65
    v_and_b32 v107, s81, v65
    v_lshlrev_b32 v108, 16, v66
    v_and_b32 v109, s81, v66
    v_lshlrev_b32 v110, 16, v67
    v_and_b32 v111, s81, v67
    v_lshlrev_b32 v112, 16, v68
    v_and_b32 v113, s81, v68
    v_lshlrev_b32 v114, 16, v69
    v_and_b32 v115, s81, v69
    v_lshlrev_b32 v116, 16, v70
    v_and_b32 v117, s81, v70
    v_lshlrev_b32 v118, 16, v71
    v_and_b32 v119, s81, v71
    v_lshlrev_b32 v120, 16, v72
    v_and_b32 v121, s81, v72
    v_lshlrev_b32 v122, 16, v73
    v_and_b32 v123, s81, v73
    v_lshlrev_b32 v124, 16, v74
    v_and_b32 v125, s81, v74
    v_lshlrev_b32 v126, 16, v75
    v_and_b32 v127, s81, v75
    v_lshlrev_b32 v128, 16, v76
    v_and_b32 v129, s81, v76
    v_lshlrev_b32 v130, 16, v77
    v_and_b32 v131, s81, v77
    v_lshlrev_b32 v132, 16, v78
    v_and_b32 v133, s81, v78
    v_lshlrev_b32 v134, 16, v79
    v_and_b32 v135, s81, v79
    v_and_b32 v144, s81, v80
    v_lshlrev_b32 v152, 16, v81
    v_and_b32 v160, s81, v81
    v_lshlrev_b32 v145, 16, v68
    v_and_b32 v146, s81, v68
    v_lshlrev_b32 v147, 16, v69
    v_and_b32 v148, s81, v69
    v_lshlrev_b32 v149, 16, v70
    v_and_b32 v150, s81, v70
    v_lshlrev_b32 v151, 16, v71
    v_lshlrev_b32 v153, 16, v72
    v_and_b32 v154, s81, v72
    v_lshlrev_b32 v155, 16, v73
    v_and_b32 v156, s81, v73
    v_lshlrev_b32 v157, 16, v74
    v_and_b32 v158, s81, v74
    v_lshlrev_b32 v159, 16, v75
    v_lshlrev_b32 v161, 16, v76
    v_and_b32 v162, s81, v76
    v_lshlrev_b32 v163, 16, v77
    v_and_b32 v164, s81, v77
    v_lshlrev_b32 v165, 16, v78
    v_and_b32 v166, s81, v78
    v_lshlrev_b32 v167, 16, v79
    v_lshlrev_b32 v186, 16, v84
    v_and_b32 v187, s81, v84
    v_lshlrev_b32 v190, 16, v85
    v_and_b32 v191, s81, v85
    v_pk_mul_f32 v[184:185], v[104:105], v[192:193]
    v_pk_mul_f32 v[188:189], v[106:107], v[192:193]
    v_pk_fma_f32 v[184:185], v[160:161], v[194:195], v[184:185]
    v_pk_fma_f32 v[188:189], v[162:163], v[194:195], v[188:189]
    v_pk_fma_f32 v[184:185], v[152:153], v[196:197], v[184:185]
    v_pk_fma_f32 v[188:189], v[154:155], v[196:197], v[188:189]
    v_pk_fma_f32 v[184:185], v[144:145], v[198:199], v[184:185]
    v_pk_fma_f32 v[188:189], v[146:147], v[198:199], v[188:189]
    v_pk_mul_f32 v[184:185], v[184:185], v[186:187]
    v_pk_mul_f32 v[188:189], v[188:189], v[190:191]
    v_cvt_pk_bf16_f32 v168, v184, v185
    v_cvt_pk_bf16_f32 v169, v188, v189
    v_lshlrev_b32 v186, 16, v86
    v_and_b32 v187, s81, v86
    v_lshlrev_b32 v190, 16, v87
    v_and_b32 v191, s81, v87
    v_pk_mul_f32 v[184:185], v[108:109], v[192:193]
    v_pk_mul_f32 v[188:189], v[110:111], v[192:193]
    v_pk_fma_f32 v[184:185], v[164:165], v[194:195], v[184:185]
    v_pk_fma_f32 v[188:189], v[166:167], v[194:195], v[188:189]
    v_pk_fma_f32 v[184:185], v[156:157], v[196:197], v[184:185]
    v_pk_fma_f32 v[188:189], v[158:159], v[196:197], v[188:189]
    v_pk_fma_f32 v[184:185], v[148:149], v[198:199], v[184:185]
    v_pk_fma_f32 v[188:189], v[150:151], v[198:199], v[188:189]
    v_pk_mul_f32 v[184:185], v[184:185], v[186:187]
    v_pk_mul_f32 v[188:189], v[188:189], v[190:191]
    v_cvt_pk_bf16_f32 v170, v184, v185
    v_cvt_pk_bf16_f32 v171, v188, v189
    v_lshlrev_b32 v186, 16, v88
    v_and_b32 v187, s81, v88
    v_lshlrev_b32 v190, 16, v89
    v_and_b32 v191, s81, v89
    v_pk_mul_f32 v[184:185], v[112:113], v[192:193]
    v_pk_mul_f32 v[188:189], v[114:115], v[192:193]
    v_pk_fma_f32 v[184:185], v[104:105], v[194:195], v[184:185]
    v_pk_fma_f32 v[188:189], v[106:107], v[194:195], v[188:189]
    v_pk_fma_f32 v[184:185], v[160:161], v[196:197], v[184:185]
    v_pk_fma_f32 v[188:189], v[162:163], v[196:197], v[188:189]
    v_pk_fma_f32 v[184:185], v[152:153], v[198:199], v[184:185]
    v_pk_fma_f32 v[188:189], v[154:155], v[198:199], v[188:189]
    v_pk_mul_f32 v[184:185], v[184:185], v[186:187]
    v_pk_mul_f32 v[188:189], v[188:189], v[190:191]
    v_cvt_pk_bf16_f32 v172, v184, v185
    v_cvt_pk_bf16_f32 v173, v188, v189
    v_lshlrev_b32 v186, 16, v90
    v_and_b32 v187, s81, v90
    v_lshlrev_b32 v190, 16, v91
    v_and_b32 v191, s81, v91
    v_pk_mul_f32 v[184:185], v[116:117], v[192:193]
    v_pk_mul_f32 v[188:189], v[118:119], v[192:193]
    v_pk_fma_f32 v[184:185], v[108:109], v[194:195], v[184:185]
    v_pk_fma_f32 v[188:189], v[110:111], v[194:195], v[188:189]
    v_pk_fma_f32 v[184:185], v[164:165], v[196:197], v[184:185]
    v_pk_fma_f32 v[188:189], v[166:167], v[196:197], v[188:189]
    v_pk_fma_f32 v[184:185], v[156:157], v[198:199], v[184:185]
    v_pk_fma_f32 v[188:189], v[158:159], v[198:199], v[188:189]
    v_pk_mul_f32 v[184:185], v[184:185], v[186:187]
    v_pk_mul_f32 v[188:189], v[188:189], v[190:191]
    v_cvt_pk_bf16_f32 v174, v184, v185
    v_cvt_pk_bf16_f32 v175, v188, v189
    v_lshlrev_b32 v186, 16, v92
    v_and_b32 v187, s81, v92
    v_lshlrev_b32 v190, 16, v93
    v_and_b32 v191, s81, v93
    v_pk_mul_f32 v[184:185], v[120:121], v[192:193]
    v_pk_mul_f32 v[188:189], v[122:123], v[192:193]
    v_pk_fma_f32 v[184:185], v[112:113], v[194:195], v[184:185]
    v_pk_fma_f32 v[188:189], v[114:115], v[194:195], v[188:189]
    v_pk_fma_f32 v[184:185], v[104:105], v[196:197], v[184:185]
    v_pk_fma_f32 v[188:189], v[106:107], v[196:197], v[188:189]
    v_pk_fma_f32 v[184:185], v[160:161], v[198:199], v[184:185]
    v_pk_fma_f32 v[188:189], v[162:163], v[198:199], v[188:189]
    v_pk_mul_f32 v[184:185], v[184:185], v[186:187]
    v_pk_mul_f32 v[188:189], v[188:189], v[190:191]
    v_cvt_pk_bf16_f32 v176, v184, v185
    v_cvt_pk_bf16_f32 v177, v188, v189
    v_lshlrev_b32 v186, 16, v94
    v_and_b32 v187, s81, v94
    v_lshlrev_b32 v190, 16, v95
    v_and_b32 v191, s81, v95
    v_pk_mul_f32 v[184:185], v[124:125], v[192:193]
    v_pk_mul_f32 v[188:189], v[126:127], v[192:193]
    v_pk_fma_f32 v[184:185], v[116:117], v[194:195], v[184:185]
    v_pk_fma_f32 v[188:189], v[118:119], v[194:195], v[188:189]
    v_pk_fma_f32 v[184:185], v[108:109], v[196:197], v[184:185]
    v_pk_fma_f32 v[188:189], v[110:111], v[196:197], v[188:189]
    v_pk_fma_f32 v[184:185], v[164:165], v[198:199], v[184:185]
    v_pk_fma_f32 v[188:189], v[166:167], v[198:199], v[188:189]
    v_pk_mul_f32 v[184:185], v[184:185], v[186:187]
    v_pk_mul_f32 v[188:189], v[188:189], v[190:191]
    v_cvt_pk_bf16_f32 v178, v184, v185
    v_cvt_pk_bf16_f32 v179, v188, v189
    v_lshlrev_b32 v186, 16, v96
    v_and_b32 v187, s81, v96
    v_lshlrev_b32 v190, 16, v97
    v_and_b32 v191, s81, v97
    v_pk_mul_f32 v[184:185], v[128:129], v[192:193]
    v_pk_mul_f32 v[188:189], v[130:131], v[192:193]
    v_pk_fma_f32 v[184:185], v[120:121], v[194:195], v[184:185]
    v_pk_fma_f32 v[188:189], v[122:123], v[194:195], v[188:189]
    v_pk_fma_f32 v[184:185], v[112:113], v[196:197], v[184:185]
    v_pk_fma_f32 v[188:189], v[114:115], v[196:197], v[188:189]
    v_pk_fma_f32 v[184:185], v[104:105], v[198:199], v[184:185]
    v_pk_fma_f32 v[188:189], v[106:107], v[198:199], v[188:189]
    v_pk_mul_f32 v[184:185], v[184:185], v[186:187]
    v_pk_mul_f32 v[188:189], v[188:189], v[190:191]
    v_cvt_pk_bf16_f32 v180, v184, v185
    v_cvt_pk_bf16_f32 v181, v188, v189
    v_lshlrev_b32 v186, 16, v98
    v_and_b32 v187, s81, v98
    v_lshlrev_b32 v190, 16, v99
    v_and_b32 v191, s81, v99
    v_pk_mul_f32 v[184:185], v[132:133], v[192:193]
    v_pk_mul_f32 v[188:189], v[134:135], v[192:193]
    v_pk_fma_f32 v[184:185], v[124:125], v[194:195], v[184:185]
    v_pk_fma_f32 v[188:189], v[126:127], v[194:195], v[188:189]
    v_pk_fma_f32 v[184:185], v[116:117], v[196:197], v[184:185]
    v_pk_fma_f32 v[188:189], v[118:119], v[196:197], v[188:189]
    v_pk_fma_f32 v[184:185], v[108:109], v[198:199], v[184:185]
    v_pk_fma_f32 v[188:189], v[110:111], v[198:199], v[188:189]
    v_pk_mul_f32 v[184:185], v[184:185], v[186:187]
    v_pk_mul_f32 v[188:189], v[188:189], v[190:191]
    v_cvt_pk_bf16_f32 v182, v184, v185
    v_cvt_pk_bf16_f32 v183, v188, v189
    s_waitcnt lgkmcnt(0)
    s_barrier
    v_mul_u32_u24 v2, 272, v1
    s_lshl_b32 s70, s68, 4
    v_add_u32 v2, s70, v2
    ds_write_b128 v2, v[168:171] offset:0
    ds_write_b128 v2, v[172:175] offset:64
    ds_write_b128 v2, v[176:179] offset:128
    ds_write_b128 v2, v[180:183] offset:192
    s_waitcnt lgkmcnt(0)
    s_barrier
    v_lshrrev_b32 v2, 4, v0
    v_mul_u32_u24 v2, 272, v2
    v_and_b32 v3, 15, v0
    v_lshl_add_u32 v2, v3, 4, v2
    v_bfe_u32 v3, v0, 2, 2
    v_add_u32 v3, s77, v3
    v_and_b32 v3, 3, v3
    v_lshlrev_b32 v3, 6, v3
    v_and_b32 v4, 3, v0
    v_lshl_add_u32 v3, v4, 4, v3
    v_lshrrev_b32 v4, 4, v0
    v_lshl_add_u32 v3, v4, 12, v3
    s_lshl_b32 s70, s76, 18
    s_lshl_b32 s71, s77, 8
    s_add_u32 s70, s70, s71
    s_add_u32 s70, s70, 10485760
    ds_read_b128 v[168:171], v2 offset:0
    ds_read_b128 v[172:175], v2 offset:4352
    ds_read_b128 v[176:179], v2 offset:8704
    ds_read_b128 v[180:183], v2 offset:13056
    s_waitcnt lgkmcnt(3)
    buffer_store_dwordx4 v[168:171], v3, s[48:51], s70 offen sc1
    s_add_u32 s70, s70, 65536
    s_waitcnt lgkmcnt(2)
    buffer_store_dwordx4 v[172:175], v3, s[48:51], s70 offen sc1
    s_add_u32 s70, s70, 65536
    s_waitcnt lgkmcnt(1)
    buffer_store_dwordx4 v[176:179], v3, s[48:51], s70 offen sc1
    s_add_u32 s70, s70, 65536
    s_waitcnt lgkmcnt(0)
    buffer_store_dwordx4 v[180:183], v3, s[48:51], s70 offen sc1
    s_waitcnt vmcnt(4)
    s_bitcmp1_b32 s79, 0
    s_cbranch_scc0 L_b_dlo
    s_lshr_b32 s88, s88, 16
L_b_dlo:
    s_lshl_b32 s88, s88, 16
    s_lshl_b32 s84, s84, 16
    v_mov_b32 v2, s84
    v_add_f32 v2, s88, v2
    v_cvt_pk_bf16_f32 v2, v2, v2
    v_mov_b32 v28, 0
    v_mov_b32 v29, 0
    v_mov_b32 v30, 0
    v_mov_b32 v31, 0
    v_mov_b32 v3, s80
    s_mov_b64 exec, 1
    ds_write_b128 v3, v[28:31] offset:0
    ds_write_b128 v3, v[28:31] offset:16
    ds_write_b128 v3, v[28:31] offset:4144
    ds_write_b128 v3, v[28:31] offset:4160
    ds_write_b16 v3, v2 offset:32
    s_mov_b64 exec, -1
    v_lshlrev_b32 v3, 4, v1
    v_add_u32 v3, s80, v3
    s_waitcnt lgkmcnt(0)
    ds_read_b128 v[64:67], v3 offset:32
    ds_read_b32 v68, v3 offset:28
    ds_read_b128 v[72:75], v3 offset:1056
    ds_read_b32 v76, v3 offset:1052
    ds_read_b128 v[80:83], v3 offset:2080
    ds_read_b32 v84, v3 offset:2076
    ds_read_b128 v[88:91], v3 offset:3104
    ds_read_b32 v92, v3 offset:3100
    s_waitcnt lgkmcnt(6)
    v_alignbit_b32 v68, v64, v68, 16
    v_alignbit_b32 v69, v65, v64, 16
    v_alignbit_b32 v70, v66, v65, 16
    v_alignbit_b32 v71, v67, v66, 16
    ds_write_b128 v3, v[68:71] offset:4176
    s_waitcnt lgkmcnt(5)
    v_alignbit_b32 v76, v72, v76, 16
    v_alignbit_b32 v77, v73, v72, 16
    v_alignbit_b32 v78, v74, v73, 16
    v_alignbit_b32 v79, v75, v74, 16
    ds_write_b128 v3, v[76:79] offset:5200
    s_waitcnt lgkmcnt(4)
    v_alignbit_b32 v84, v80, v84, 16
    v_alignbit_b32 v85, v81, v80, 16
    v_alignbit_b32 v86, v82, v81, 16
    v_alignbit_b32 v87, v83, v82, 16
    ds_write_b128 v3, v[84:87] offset:6224
    s_waitcnt lgkmcnt(3)
    v_alignbit_b32 v92, v88, v92, 16
    v_alignbit_b32 v93, v89, v88, 16
    v_alignbit_b32 v94, v90, v89, 16
    v_alignbit_b32 v95, v91, v90, 16
    ds_write_b128 v3, v[92:95] offset:7248
    s_waitcnt lgkmcnt(0)
    v_lshrrev_b32 v2, 4, v1
    v_bfe_u32 v3, v1, 2, 2
    v_and_b32 v4, 3, v1
    v_sub_u32 v4, v4, v3
    v_lshlrev_b32 v4, 3, v4
    v_lshlrev_b32 v5, 6, v2
    v_sub_u32 v4, v4, v5
    s_add_u32 s70, s80, 224
    v_add_u32 v4, s70, v4
    ds_read_b64_tr_b16 v[64:65], v4 offset:32
    ds_read_b64_tr_b16 v[66:67], v4 offset:0
    ds_read_b64_tr_b16 v[68:69], v4 offset:288
    ds_read_b64_tr_b16 v[70:71], v4 offset:256
    ds_read_b64_tr_b16 v[72:73], v4 offset:544
    ds_read_b64_tr_b16 v[74:75], v4 offset:512
    ds_read_b64_tr_b16 v[76:77], v4 offset:800
    ds_read_b64_tr_b16 v[78:79], v4 offset:768
    ds_read_b64_tr_b16 v[80:81], v4 offset:1056
    ds_read_b64_tr_b16 v[82:83], v4 offset:1024
    ds_read_b64_tr_b16 v[84:85], v4 offset:1312
    ds_read_b64_tr_b16 v[86:87], v4 offset:1280
    ds_read_b64_tr_b16 v[88:89], v4 offset:1568
    ds_read_b64_tr_b16 v[90:91], v4 offset:1536
    ds_read_b64_tr_b16 v[92:93], v4 offset:1824
    ds_read_b64_tr_b16 v[94:95], v4 offset:1792
    ds_read_b64_tr_b16 v[96:97], v4 offset:2080
    ds_read_b64_tr_b16 v[98:99], v4 offset:2048
    ds_read_b64_tr_b16 v[100:101], v4 offset:2336
    ds_read_b64_tr_b16 v[102:103], v4 offset:2304
    ds_read_b64_tr_b16 v[104:105], v4 offset:2592
    ds_read_b64_tr_b16 v[106:107], v4 offset:2560
    ds_read_b64_tr_b16 v[108:109], v4 offset:2848
    ds_read_b64_tr_b16 v[110:111], v4 offset:2816
    ds_read_b64_tr_b16 v[112:113], v4 offset:3104
    ds_read_b64_tr_b16 v[114:115], v4 offset:3072
    ds_read_b64_tr_b16 v[116:117], v4 offset:3360
    ds_read_b64_tr_b16 v[118:119], v4 offset:3328
    ds_read_b64_tr_b16 v[120:121], v4 offset:3616
    ds_read_b64_tr_b16 v[122:123], v4 offset:3584
    ds_read_b64_tr_b16 v[124:125], v4 offset:3872
    ds_read_b64_tr_b16 v[126:127], v4 offset:3840
    ds_read_b64_tr_b16 v[128:129], v4 offset:4176
    ds_read_b64_tr_b16 v[130:131], v4 offset:4144
    ds_read_b64_tr_b16 v[132:133], v4 offset:4432
    ds_read_b64_tr_b16 v[134:135], v4 offset:4400
    ds_read_b64_tr_b16 v[136:137], v4 offset:4688
    ds_read_b64_tr_b16 v[138:139], v4 offset:4656
    ds_read_b64_tr_b16 v[140:141], v4 offset:4944
    ds_read_b64_tr_b16 v[142:143], v4 offset:4912
    ds_read_b64_tr_b16 v[144:145], v4 offset:5200
    ds_read_b64_tr_b16 v[146:147], v4 offset:5168
    ds_read_b64_tr_b16 v[148:149], v4 offset:5456
    ds_read_b64_tr_b16 v[150:151], v4 offset:5424
    ds_read_b64_tr_b16 v[152:153], v4 offset:5712
    ds_read_b64_tr_b16 v[154:155], v4 offset:5680
    ds_read_b64_tr_b16 v[156:157], v4 offset:5968
    ds_read_b64_tr_b16 v[158:159], v4 offset:5936
    ds_read_b64_tr_b16 v[160:161], v4 offset:6224
    ds_read_b64_tr_b16 v[162:163], v4 offset:6192
    ds_read_b64_tr_b16 v[164:165], v4 offset:6480
    ds_read_b64_tr_b16 v[166:167], v4 offset:6448
    ds_read_b64_tr_b16 v[168:169], v4 offset:6736
    ds_read_b64_tr_b16 v[170:171], v4 offset:6704
    ds_read_b64_tr_b16 v[172:173], v4 offset:6992
    ds_read_b64_tr_b16 v[174:175], v4 offset:6960
    ds_read_b64_tr_b16 v[176:177], v4 offset:7248
    ds_read_b64_tr_b16 v[178:179], v4 offset:7216
    ds_read_b64_tr_b16 v[180:181], v4 offset:7504
    ds_read_b64_tr_b16 v[182:183], v4 offset:7472
    ds_read_b64_tr_b16 v[184:185], v4 offset:7760
    ds_read_b64_tr_b16 v[186:187], v4 offset:7728
    ds_read_b64_tr_b16 v[188:189], v4 offset:8016
    ds_read_b64_tr_b16 v[190:191], v4 offset:7984
    s_waitcnt vmcnt(0)
    s_cmp_lg_u32 s68, 0
    s_cbranch_scc1 L_nonce_skip_b
    v_readfirstlane_b32 s69, v37
    s_nop 3
    s_cmp_lg_u32 s69, 0
    s_cbranch_scc1 L_nonce_skip_b
    s_and_b32 s70, s2, 63
    s_lshl_b32 s70, s70, 2
    v_mov_b32 v4, s70
    s_mov_b32 s92, 0
    s_nop 3
L_nonce_b:
    buffer_load_dword v5, v4, s[52:55], 0 offen sc1
    s_waitcnt vmcnt(0)
    v_readfirstlane_b32 s69, v5
    s_add_u32 s92, s92, 1
    s_cmp_gt_u32 s92, 400000
    s_cbranch_scc1 L_nonce_done_b
    s_nop 0
    s_cmp_eq_u32 s69, 0
    s_cbranch_scc0 L_nonce_done_b
    s_sleep 4
    s_branch L_nonce_b
L_nonce_done_b:
    s_nop 1
L_nonce_skip_b:
    s_barrier
    s_cmp_lg_u32 s68, 0
    s_cbranch_scc1 L_sig_skip_b1
    s_lshl_b32 s70, s76, 4
    s_add_u32 s70, s70, s77
    s_lshl_b32 s70, s70, 7
    s_add_u32 s70, s70, 18939904
    v_lshlrev_b32 v4, 7, v1
    v_add_u32 v4, s70, v4
    v_mov_b32 v5, s69
    s_mov_b64 s[90:91], exec
    s_mov_b64 exec, 0x1
    buffer_store_dword v5, v4, s[48:51], 0 offen sc1
    s_mov_b64 exec, s[90:91]
    s_nop 1
L_sig_skip_b1:
    v_lshrrev_b32 v2, 3, v1
    v_and_b32 v3, 7, v1
    v_xor_b32 v3, v3, v2
    v_lshlrev_b32 v3, 4, v3
    v_lshl_add_u32 v6, v2, 11, v3
    s_lshl_b32 s70, s77, 18
    s_lshl_b32 s71, s68, 16
    s_add_u32 s70, s70, s71
    s_lshl_b32 s71, s76, 7
    s_add_u32 s70, s70, s71
    s_mov_b32 s85, s70
    s_mul_i32 s82, s68, 4608
    v_and_b32 v2, 15, v1
    v_lshrrev_b32 v3, 4, v1
    v_lshlrev_b32 v4, 2, v2
    v_lshl_add_u32 v4, v3, 3, v4
    v_add_u32 v5, 4294967268, v4
    v_ashrrev_i32 v7, 5, v5
    v_and_b32 v5, 31, v5
    v_lshlrev_b32 v5, 1, v5
    v_lshl_add_u32 v5, v7, 8, v5
    s_add_u32 s71, s82, 256
    v_add_u32 v5, s71, v5
    v_add_u32 v8, 0, v7
    v_and_b32 v8, 3, v8
    v_lshl_add_u32 v24, v8, 6, v5
    v_add_u32 v8, 1, v7
    v_and_b32 v8, 3, v8
    v_lshl_add_u32 v26, v8, 6, v5
    v_add_u32 v8, 2, v7
    v_and_b32 v8, 3, v8
    v_lshl_add_u32 v28, v8, 6, v5
    v_add_u32 v8, 3, v7
    v_and_b32 v8, 3, v8
    v_lshl_add_u32 v30, v8, 6, v5
    v_add_u32 v5, 4294967272, v4
    v_ashrrev_i32 v7, 5, v5
    v_and_b32 v5, 31, v5
    v_lshlrev_b32 v5, 1, v5
    v_lshl_add_u32 v5, v7, 8, v5
    s_add_u32 s71, s82, 256
    v_add_u32 v5, s71, v5
    v_add_u32 v8, 0, v7
    v_and_b32 v8, 3, v8
    v_lshl_add_u32 v25, v8, 6, v5
    v_add_u32 v8, 1, v7
    v_and_b32 v8, 3, v8
    v_lshl_add_u32 v27, v8, 6, v5
    v_add_u32 v8, 2, v7
    v_and_b32 v8, 3, v8
    v_lshl_add_u32 v29, v8, 6, v5
    v_add_u32 v8, 3, v7
    v_and_b32 v8, 3, v8
    v_lshl_add_u32 v31, v8, 6, v5
    v_subrev_u32 v8, 16, v1
    v_add_u32 v9, 47, v1
    v_cmp_gt_u32 vcc, 16, v1
    s_nop 1
    v_cndmask_b32 v8, v8, v9, vcc
    v_mov_b32 v9, 63
    v_cmp_eq_u32 vcc, 0, v1
    s_nop 1
    v_cndmask_b32 v8, v8, v9, vcc
    v_lshlrev_b32 v35, 2, v8
    v_lshlrev_b32 v36, 4, v1
    s_lshl_b32 s83, s76, 18
    s_lshl_b32 s71, s77, 14
    s_add_u32 s83, s83, s71
    s_lshl_b32 s71, s68, 12
    s_add_u32 s83, s83, s71
    s_add_u32 s83, s83, 10485760
    v_lshrrev_b32 v2, 4, v1
    v_and_b32 v33, 1, v2
    v_lshlrev_b32 v33, 1, v33
    v_bfe_u32 v4, v1, 3, 1
    v_add_u32 v33, v33, v4
    v_lshlrev_b32 v33, 14, v33
    v_and_b32 v4, 7, v1
    v_lshl_add_u32 v33, v4, 5, v33
    v_lshrrev_b32 v2, 1, v2
    v_lshl_add_u32 v33, v2, 4, v33
    s_lshl_b32 s86, s76, 18
    s_lshl_b32 s71, s77, 10
    s_add_u32 s86, s86, s71
    s_lshl_b32 s71, s68, 8
    s_add_u32 s86, s86, s71
    s_add_u32 s86, s86, 14680064
    s_waitcnt lgkmcnt(0)
    s_cmp_lg_u32 s68, 0
    s_cbranch_scc1 L_wait_skip_b1
    s_lshl_b32 s70, s76, 11
    s_add_u32 s70, s70, 18939904
    v_lshlrev_b32 v8, 7, v1
    v_add_u32 v8, s70, v8
    s_mov_b64 s[90:91], exec
    s_mov_b64 exec, 0xffff
    s_sleep 12
    s_mov_b32 s92, 0
    s_nop 1
L_poll_b1:
    buffer_load_dword v10, v8, s[48:51], 0 offen sc1
    s_waitcnt vmcnt(0)
    v_xor_b32 v10, s69, v10
    v_cmp_ne_u32 vcc, 0, v10
    s_add_u32 s92, s92, 1
    s_cmp_gt_u32 s92, 400000
    s_cbranch_scc1 L_poll_done_b1
    s_nop 1
    s_cmp_eq_u64 vcc, 0
    s_cbranch_scc1 L_poll_done_b1
    s_sleep 4
    s_branch L_poll_b1
L_poll_done_b1:
    s_mov_b64 exec, s[90:91]
    s_nop 1
L_wait_skip_b1:
    s_barrier
    s_add_u32 m0, s82, 512
    s_nop 0
    buffer_load_dwordx4 v36, s[48:51], s83 offen offset:0 sc1 lds
    buffer_load_dwordx4 v36, s[48:51], s83 offen offset:1024 sc1 lds
    buffer_load_dwordx4 v36, s[48:51], s83 offen offset:2048 sc1 lds
    buffer_load_dwordx4 v36, s[48:51], s83 offen offset:3072 sc1 lds
    s_add_u32 m0, s80, 0
    s_add_u32 s71, s85, 0
    buffer_load_dwordx4 v6, s[32:35], s71 offen nt lds
    s_add_u32 m0, s80, 1024
    s_add_u32 s71, s85, 16384
    buffer_load_dwordx4 v6, s[32:35], s71 offen nt lds
    s_add_u32 m0, s80, 2048
    s_add_u32 s71, s85, 32768
    buffer_load_dwordx4 v6, s[32:35], s71 offen nt lds
    s_add_u32 m0, s80, 3072
    s_add_u32 s71, s85, 49152
    buffer_load_dwordx4 v6, s[32:35], s71 offen nt lds
    v_mov_b32 v8, 0
    v_mov_b32 v9, 0
    v_mov_b32 v10, 0
    v_mov_b32 v11, 0
    v_add_u32 v2, s82, v36
    s_mov_b32 exec_hi, 0
    ds_write_b128 v2, v[8:11]
    s_mov_b32 exec_hi, -1
    s_waitcnt vmcnt(4) lgkmcnt(0)
    ds_read_b64 v[240:241], v26 offset:0
    ds_read_b64 v[242:243], v27 offset:0
    ds_read_b64 v[244:245], v24 offset:3840
    ds_read_b64 v[246:247], v25 offset:3840
    ds_read_b64 v[248:249], v28 offset:256
    ds_read_b64 v[250:251], v29 offset:256
    ds_read_b64 v[252:253], v30 offset:3584
    ds_read_b64 v[254:255], v31 offset:3584
    s_waitcnt lgkmcnt(6)
    v_mfma_f32_16x16x32_bf16 v[194:197], v[68:71], v[240:243], 0
    v_mfma_f32_16x16x32_bf16 v[200:203], v[76:79], v[240:243], 0
    v_mfma_f32_16x16x32_bf16 v[206:209], v[84:87], v[240:243], 0
    v_mfma_f32_16x16x32_bf16 v[212:215], v[92:95], v[240:243], 0
    v_mfma_f32_16x16x32_bf16 v[218:221], v[100:103], v[240:243], 0
    v_mfma_f32_16x16x32_bf16 v[224:227], v[108:111], v[240:243], 0
    v_mfma_f32_16x16x32_bf16 v[230:233], v[116:119], v[240:243], 0
    v_mfma_f32_16x16x32_bf16 v[236:239], v[124:127], v[240:243], 0
    ds_read_b64 v[240:241], v30 offset:512
    ds_read_b64 v[242:243], v31 offset:512
    s_waitcnt lgkmcnt(6)
    v_mfma_f32_16x16x32_bf16 v[236:239], v[64:67], v[244:247], v[236:239]
    ds_read_b64 v[244:245], v28 offset:3328
    ds_read_b64 v[246:247], v29 offset:3328
    s_waitcnt lgkmcnt(6)
    v_mfma_f32_16x16x32_bf16 v[194:197], v[64:67], v[248:251], v[194:197]
    v_mfma_f32_16x16x32_bf16 v[200:203], v[72:75], v[248:251], v[200:203]
    v_mfma_f32_16x16x32_bf16 v[206:209], v[80:83], v[248:251], v[206:209]
    v_mfma_f32_16x16x32_bf16 v[212:215], v[88:91], v[248:251], v[212:215]
    v_mfma_f32_16x16x32_bf16 v[218:221], v[96:99], v[248:251], v[218:221]
    v_mfma_f32_16x16x32_bf16 v[224:227], v[104:107], v[248:251], v[224:227]
    v_mfma_f32_16x16x32_bf16 v[230:233], v[112:115], v[248:251], v[230:233]
    v_mfma_f32_16x16x32_bf16 v[236:239], v[120:123], v[248:251], v[236:239]
    ds_read_b64 v[248:249], v24 offset:768
    ds_read_b64 v[250:251], v25 offset:768
    s_waitcnt lgkmcnt(6)
    v_mfma_f32_16x16x32_bf16 v[236:239], v[68:71], v[252:255], v[236:239]
    ds_read_b64 v[252:253], v26 offset:3072
    ds_read_b64 v[254:255], v27 offset:3072
    s_waitcnt lgkmcnt(6)
    v_mfma_f32_16x16x32_bf16 v[200:203], v[68:71], v[240:243], v[200:203]
    v_mfma_f32_16x16x32_bf16 v[206:209], v[76:79], v[240:243], v[206:209]
    v_mfma_f32_16x16x32_bf16 v[212:215], v[84:87], v[240:243], v[212:215]
    v_mfma_f32_16x16x32_bf16 v[218:221], v[92:95], v[240:243], v[218:221]
    v_mfma_f32_16x16x32_bf16 v[224:227], v[100:103], v[240:243], v[224:227]
    v_mfma_f32_16x16x32_bf16 v[230:233], v[108:111], v[240:243], v[230:233]
    v_mfma_f32_16x16x32_bf16 v[236:239], v[116:119], v[240:243], v[236:239]
    ds_read_b64 v[240:241], v26 offset:1024
    ds_read_b64 v[242:243], v27 offset:1024
    s_waitcnt lgkmcnt(6)
    v_mfma_f32_16x16x32_bf16 v[230:233], v[64:67], v[244:247], v[230:233]
    v_mfma_f32_16x16x32_bf16 v[236:239], v[72:75], v[244:247], v[236:239]
    ds_read_b64 v[244:245], v24 offset:2816
    ds_read_b64 v[246:247], v25 offset:2816
    s_waitcnt lgkmcnt(6)
    v_mfma_f32_16x16x32_bf16 v[200:203], v[64:67], v[248:251], v[200:203]
    v_mfma_f32_16x16x32_bf16 v[206:209], v[72:75], v[248:251], v[206:209]
    v_mfma_f32_16x16x32_bf16 v[212:215], v[80:83], v[248:251], v[212:215]
    v_mfma_f32_16x16x32_bf16 v[218:221], v[88:91], v[248:251], v[218:221]
    v_mfma_f32_16x16x32_bf16 v[224:227], v[96:99], v[248:251], v[224:227]
    v_mfma_f32_16x16x32_bf16 v[230:233], v[104:107], v[248:251], v[230:233]
    v_mfma_f32_16x16x32_bf16 v[236:239], v[112:115], v[248:251], v[236:239]
    ds_read_b64 v[248:249], v28 offset:1280
    ds_read_b64 v[250:251], v29 offset:1280
    s_waitcnt lgkmcnt(6)
    v_mfma_f32_16x16x32_bf16 v[230:233], v[68:71], v[252:255], v[230:233]
    v_mfma_f32_16x16x32_bf16 v[236:239], v[76:79], v[252:255], v[236:239]
    ds_read_b64 v[252:253], v30 offset:2560
    ds_read_b64 v[254:255], v31 offset:2560
    s_waitcnt lgkmcnt(6)
    v_mfma_f32_16x16x32_bf16 v[206:209], v[68:71], v[240:243], v[206:209]
    v_mfma_f32_16x16x32_bf16 v[212:215], v[76:79], v[240:243], v[212:215]
    v_mfma_f32_16x16x32_bf16 v[218:221], v[84:87], v[240:243], v[218:221]
    v_mfma_f32_16x16x32_bf16 v[224:227], v[92:95], v[240:243], v[224:227]
    v_mfma_f32_16x16x32_bf16 v[230:233], v[100:103], v[240:243], v[230:233]
    v_mfma_f32_16x16x32_bf16 v[236:239], v[108:111], v[240:243], v[236:239]
    ds_read_b64 v[240:241], v30 offset:1536
    ds_read_b64 v[242:243], v31 offset:1536
    s_waitcnt lgkmcnt(6)
    v_mfma_f32_16x16x32_bf16 v[224:227], v[64:67], v[244:247], v[224:227]
    v_mfma_f32_16x16x32_bf16 v[230:233], v[72:75], v[244:247], v[230:233]
    v_mfma_f32_16x16x32_bf16 v[236:239], v[80:83], v[244:247], v[236:239]
    ds_read_b64 v[244:245], v28 offset:2304
    ds_read_b64 v[246:247], v29 offset:2304
    s_waitcnt lgkmcnt(6)
    v_mfma_f32_16x16x32_bf16 v[206:209], v[64:67], v[248:251], v[206:209]
    v_mfma_f32_16x16x32_bf16 v[212:215], v[72:75], v[248:251], v[212:215]
    v_mfma_f32_16x16x32_bf16 v[218:221], v[80:83], v[248:251], v[218:221]
    v_mfma_f32_16x16x32_bf16 v[224:227], v[88:91], v[248:251], v[224:227]
    v_mfma_f32_16x16x32_bf16 v[230:233], v[96:99], v[248:251], v[230:233]
    v_mfma_f32_16x16x32_bf16 v[236:239], v[104:107], v[248:251], v[236:239]
    ds_read_b64 v[248:249], v24 offset:1792
    ds_read_b64 v[250:251], v25 offset:1792
    s_waitcnt lgkmcnt(6)
    v_mfma_f32_16x16x32_bf16 v[224:227], v[68:71], v[252:255], v[224:227]
    v_mfma_f32_16x16x32_bf16 v[230:233], v[76:79], v[252:255], v[230:233]
    v_mfma_f32_16x16x32_bf16 v[236:239], v[84:87], v[252:255], v[236:239]
    ds_read_b64 v[252:253], v26 offset:2048
    ds_read_b64 v[254:255], v27 offset:2048
    s_waitcnt lgkmcnt(6)
    v_mfma_f32_16x16x32_bf16 v[212:215], v[68:71], v[240:243], v[212:215]
    v_mfma_f32_16x16x32_bf16 v[218:221], v[76:79], v[240:243], v[218:221]
    v_mfma_f32_16x16x32_bf16 v[224:227], v[84:87], v[240:243], v[224:227]
    v_mfma_f32_16x16x32_bf16 v[230:233], v[92:95], v[240:243], v[230:233]
    v_mfma_f32_16x16x32_bf16 v[236:239], v[100:103], v[240:243], v[236:239]
    ds_read_b64 v[240:241], v28 offset:0
    ds_read_b64 v[242:243], v29 offset:0
    s_waitcnt lgkmcnt(6)
    v_mfma_f32_16x16x32_bf16 v[218:221], v[64:67], v[244:247], v[218:221]
    v_mfma_f32_16x16x32_bf16 v[224:227], v[72:75], v[244:247], v[224:227]
    v_mfma_f32_16x16x32_bf16 v[230:233], v[80:83], v[244:247], v[230:233]
    v_mfma_f32_16x16x32_bf16 v[236:239], v[88:91], v[244:247], v[236:239]
    ds_read_b64 v[244:245], v26 offset:3840
    ds_read_b64 v[246:247], v27 offset:3840
    s_waitcnt lgkmcnt(6)
    v_mfma_f32_16x16x32_bf16 v[212:215], v[64:67], v[248:251], v[212:215]
    v_mfma_f32_16x16x32_bf16 v[218:221], v[72:75], v[248:251], v[218:221]
    v_mfma_f32_16x16x32_bf16 v[224:227], v[80:83], v[248:251], v[224:227]
    v_mfma_f32_16x16x32_bf16 v[230:233], v[88:91], v[248:251], v[230:233]
    v_mfma_f32_16x16x32_bf16 v[236:239], v[96:99], v[248:251], v[236:239]
    ds_read_b64 v[248:249], v30 offset:256
    ds_read_b64 v[250:251], v31 offset:256
    s_waitcnt lgkmcnt(6)
    v_mfma_f32_16x16x32_bf16 v[218:221], v[68:71], v[252:255], v[218:221]
    v_mfma_f32_16x16x32_bf16 v[224:227], v[76:79], v[252:255], v[224:227]
    v_mfma_f32_16x16x32_bf16 v[230:233], v[84:87], v[252:255], v[230:233]
    v_mfma_f32_16x16x32_bf16 v[236:239], v[92:95], v[252:255], v[236:239]
    ds_read_b64 v[252:253], v24 offset:3584
    ds_read_b64 v[254:255], v25 offset:3584
    s_waitcnt lgkmcnt(6)
    v_mfma_f32_16x16x32_bf16 v[194:197], v[132:135], v[240:243], v[194:197]
    v_mfma_f32_16x16x32_bf16 v[200:203], v[140:143], v[240:243], v[200:203]
    v_mfma_f32_16x16x32_bf16 v[206:209], v[148:151], v[240:243], v[206:209]
    v_mfma_f32_16x16x32_bf16 v[212:215], v[156:159], v[240:243], v[212:215]
    v_mfma_f32_16x16x32_bf16 v[218:221], v[164:167], v[240:243], v[218:221]
    v_mfma_f32_16x16x32_bf16 v[224:227], v[172:175], v[240:243], v[224:227]
    v_mfma_f32_16x16x32_bf16 v[230:233], v[180:183], v[240:243], v[230:233]
    v_mfma_f32_16x16x32_bf16 v[236:239], v[188:191], v[240:243], v[236:239]
    ds_read_b64 v[240:241], v24 offset:512
    ds_read_b64 v[242:243], v25 offset:512
    s_waitcnt lgkmcnt(6)
    v_mfma_f32_16x16x32_bf16 v[236:239], v[128:131], v[244:247], v[236:239]
    ds_read_b64 v[244:245], v30 offset:3328
    ds_read_b64 v[246:247], v31 offset:3328
    s_waitcnt lgkmcnt(6)
    v_mfma_f32_16x16x32_bf16 v[194:197], v[128:131], v[248:251], v[194:197]
    v_mfma_f32_16x16x32_bf16 v[200:203], v[136:139], v[248:251], v[200:203]
    v_mfma_f32_16x16x32_bf16 v[206:209], v[144:147], v[248:251], v[206:209]
    v_mfma_f32_16x16x32_bf16 v[212:215], v[152:155], v[248:251], v[212:215]
    v_mfma_f32_16x16x32_bf16 v[218:221], v[160:163], v[248:251], v[218:221]
    v_mfma_f32_16x16x32_bf16 v[224:227], v[168:171], v[248:251], v[224:227]
    v_mfma_f32_16x16x32_bf16 v[230:233], v[176:179], v[248:251], v[230:233]
    v_mfma_f32_16x16x32_bf16 v[236:239], v[184:187], v[248:251], v[236:239]
    ds_read_b64 v[248:249], v26 offset:768
    ds_read_b64 v[250:251], v27 offset:768
    s_waitcnt lgkmcnt(6)
    v_mfma_f32_16x16x32_bf16 v[236:239], v[132:135], v[252:255], v[236:239]
    ds_read_b64 v[252:253], v28 offset:3072
    ds_read_b64 v[254:255], v29 offset:3072
    s_waitcnt lgkmcnt(6)
    v_mfma_f32_16x16x32_bf16 v[200:203], v[132:135], v[240:243], v[200:203]
    v_mfma_f32_16x16x32_bf16 v[206:209], v[140:143], v[240:243], v[206:209]
    v_mfma_f32_16x16x32_bf16 v[212:215], v[148:151], v[240:243], v[212:215]
    v_mfma_f32_16x16x32_bf16 v[218:221], v[156:159], v[240:243], v[218:221]
    v_mfma_f32_16x16x32_bf16 v[224:227], v[164:167], v[240:243], v[224:227]
    v_mfma_f32_16x16x32_bf16 v[230:233], v[172:175], v[240:243], v[230:233]
    v_mfma_f32_16x16x32_bf16 v[236:239], v[180:183], v[240:243], v[236:239]
    ds_read_b64 v[240:241], v28 offset:1024
    ds_read_b64 v[242:243], v29 offset:1024
    s_waitcnt lgkmcnt(6)
    v_mfma_f32_16x16x32_bf16 v[230:233], v[128:131], v[244:247], v[230:233]
    v_mfma_f32_16x16x32_bf16 v[236:239], v[136:139], v[244:247], v[236:239]
    ds_read_b64 v[244:245], v26 offset:2816
    ds_read_b64 v[246:247], v27 offset:2816
    s_waitcnt lgkmcnt(6)
    v_mfma_f32_16x16x32_bf16 v[200:203], v[128:131], v[248:251], v[200:203]
    v_mfma_f32_16x16x32_bf16 v[206:209], v[136:139], v[248:251], v[206:209]
    v_mfma_f32_16x16x32_bf16 v[212:215], v[144:147], v[248:251], v[212:215]
    v_mfma_f32_16x16x32_bf16 v[218:221], v[152:155], v[248:251], v[218:221]
    v_mfma_f32_16x16x32_bf16 v[224:227], v[160:163], v[248:251], v[224:227]
    v_mfma_f32_16x16x32_bf16 v[230:233], v[168:171], v[248:251], v[230:233]
    v_mfma_f32_16x16x32_bf16 v[236:239], v[176:179], v[248:251], v[236:239]
    ds_read_b64 v[248:249], v30 offset:1280
    ds_read_b64 v[250:251], v31 offset:1280
    s_waitcnt lgkmcnt(6)
    v_mfma_f32_16x16x32_bf16 v[230:233], v[132:135], v[252:255], v[230:233]
    v_mfma_f32_16x16x32_bf16 v[236:239], v[140:143], v[252:255], v[236:239]
    ds_read_b64 v[252:253], v24 offset:2560
    ds_read_b64 v[254:255], v25 offset:2560
    s_waitcnt lgkmcnt(6)
    v_mfma_f32_16x16x32_bf16 v[206:209], v[132:135], v[240:243], v[206:209]
    v_mfma_f32_16x16x32_bf16 v[212:215], v[140:143], v[240:243], v[212:215]
    v_mfma_f32_16x16x32_bf16 v[218:221], v[148:151], v[240:243], v[218:221]
    v_mfma_f32_16x16x32_bf16 v[224:227], v[156:159], v[240:243], v[224:227]
    v_mfma_f32_16x16x32_bf16 v[230:233], v[164:167], v[240:243], v[230:233]
    v_mfma_f32_16x16x32_bf16 v[236:239], v[172:175], v[240:243], v[236:239]
    ds_read_b64 v[240:241], v24 offset:1536
    ds_read_b64 v[242:243], v25 offset:1536
    s_waitcnt lgkmcnt(6)
    v_mfma_f32_16x16x32_bf16 v[224:227], v[128:131], v[244:247], v[224:227]
    v_mfma_f32_16x16x32_bf16 v[230:233], v[136:139], v[244:247], v[230:233]
    v_mfma_f32_16x16x32_bf16 v[236:239], v[144:147], v[244:247], v[236:239]
    ds_read_b64 v[244:245], v30 offset:2304
    ds_read_b64 v[246:247], v31 offset:2304
    s_waitcnt lgkmcnt(6)
    v_mfma_f32_16x16x32_bf16 v[206:209], v[128:131], v[248:251], v[206:209]
    v_mfma_f32_16x16x32_bf16 v[212:215], v[136:139], v[248:251], v[212:215]
    v_mfma_f32_16x16x32_bf16 v[218:221], v[144:147], v[248:251], v[218:221]
    v_mfma_f32_16x16x32_bf16 v[224:227], v[152:155], v[248:251], v[224:227]
    v_mfma_f32_16x16x32_bf16 v[230:233], v[160:163], v[248:251], v[230:233]
    v_mfma_f32_16x16x32_bf16 v[236:239], v[168:171], v[248:251], v[236:239]
    ds_read_b64 v[248:249], v26 offset:1792
    ds_read_b64 v[250:251], v27 offset:1792
    s_waitcnt lgkmcnt(6)
    v_mfma_f32_16x16x32_bf16 v[224:227], v[132:135], v[252:255], v[224:227]
    v_mfma_f32_16x16x32_bf16 v[230:233], v[140:143], v[252:255], v[230:233]
    v_mfma_f32_16x16x32_bf16 v[236:239], v[148:151], v[252:255], v[236:239]
    ds_read_b64 v[252:253], v28 offset:2048
    ds_read_b64 v[254:255], v29 offset:2048
    s_waitcnt lgkmcnt(6)
    v_mfma_f32_16x16x32_bf16 v[212:215], v[132:135], v[240:243], v[212:215]
    v_mfma_f32_16x16x32_bf16 v[218:221], v[140:143], v[240:243], v[218:221]
    v_mfma_f32_16x16x32_bf16 v[224:227], v[148:151], v[240:243], v[224:227]
    v_mfma_f32_16x16x32_bf16 v[230:233], v[156:159], v[240:243], v[230:233]
    v_mfma_f32_16x16x32_bf16 v[236:239], v[164:167], v[240:243], v[236:239]
    ds_read_b64 v[240:241], v30 offset:0
    ds_read_b64 v[242:243], v31 offset:0
    s_waitcnt lgkmcnt(6)
    v_mfma_f32_16x16x32_bf16 v[218:221], v[128:131], v[244:247], v[218:221]
    v_mfma_f32_16x16x32_bf16 v[224:227], v[136:139], v[244:247], v[224:227]
    v_mfma_f32_16x16x32_bf16 v[230:233], v[144:147], v[244:247], v[230:233]
    v_mfma_f32_16x16x32_bf16 v[236:239], v[152:155], v[244:247], v[236:239]
    ds_read_b64 v[244:245], v28 offset:3840
    ds_read_b64 v[246:247], v29 offset:3840
    s_waitcnt lgkmcnt(6)
    v_mfma_f32_16x16x32_bf16 v[212:215], v[128:131], v[248:251], v[212:215]
    v_mfma_f32_16x16x32_bf16 v[218:221], v[136:139], v[248:251], v[218:221]
    v_mfma_f32_16x16x32_bf16 v[224:227], v[144:147], v[248:251], v[224:227]
    v_mfma_f32_16x16x32_bf16 v[230:233], v[152:155], v[248:251], v[230:233]
    v_mfma_f32_16x16x32_bf16 v[236:239], v[160:163], v[248:251], v[236:239]
    ds_read_b64 v[248:249], v24 offset:256
    ds_read_b64 v[250:251], v25 offset:256
    s_waitcnt lgkmcnt(6)
    v_mfma_f32_16x16x32_bf16 v[218:221], v[132:135], v[252:255], v[218:221]
    v_mfma_f32_16x16x32_bf16 v[224:227], v[140:143], v[252:255], v[224:227]
    v_mfma_f32_16x16x32_bf16 v[230:233], v[148:151], v[252:255], v[230:233]
    v_mfma_f32_16x16x32_bf16 v[236:239], v[156:159], v[252:255], v[236:239]
    v_cmp_eq_u32 vcc, 63, v1
    s_nop 1
    v_cndmask_b32 v8, v196, 0, vcc
    ds_bpermute_b32 v192, v35, v8
    v_cndmask_b32 v9, v197, 0, vcc
    ds_bpermute_b32 v193, v35, v9
    v_cndmask_b32 v10, v202, v196, vcc
    ds_bpermute_b32 v198, v35, v10
    v_cndmask_b32 v11, v203, v197, vcc
    ds_bpermute_b32 v199, v35, v11
    v_cndmask_b32 v8, v208, v202, vcc
    ds_bpermute_b32 v204, v35, v8
    v_cndmask_b32 v9, v209, v203, vcc
    ds_bpermute_b32 v205, v35, v9
    v_cndmask_b32 v10, v214, v208, vcc
    ds_bpermute_b32 v210, v35, v10
    v_cndmask_b32 v11, v215, v209, vcc
    ds_bpermute_b32 v211, v35, v11
    v_cndmask_b32 v8, v220, v214, vcc
    ds_bpermute_b32 v216, v35, v8
    v_cndmask_b32 v9, v221, v215, vcc
    ds_bpermute_b32 v217, v35, v9
    v_cndmask_b32 v10, v226, v220, vcc
    ds_bpermute_b32 v222, v35, v10
    v_cndmask_b32 v11, v227, v221, vcc
    ds_bpermute_b32 v223, v35, v11
    v_cndmask_b32 v8, v232, v226, vcc
    ds_bpermute_b32 v228, v35, v8
    v_cndmask_b32 v9, v233, v227, vcc
    ds_bpermute_b32 v229, v35, v9
    v_cndmask_b32 v10, v238, v232, vcc
    ds_bpermute_b32 v234, v35, v10
    v_cndmask_b32 v11, v239, v233, vcc
    ds_bpermute_b32 v235, v35, v11
    ds_read_b64 v[252:253], v26 offset:3584
    ds_read_b64 v[254:255], v27 offset:3584
    s_waitcnt lgkmcnt(14)
    v_mfma_f32_16x16x32_bf16 v[192:195], v[68:71], v[240:243], v[192:195]
    v_mfma_f32_16x16x32_bf16 v[198:201], v[76:79], v[240:243], v[198:201]
    s_waitcnt lgkmcnt(12)
    v_mfma_f32_16x16x32_bf16 v[204:207], v[84:87], v[240:243], v[204:207]
    s_waitcnt lgkmcnt(10)
    v_mfma_f32_16x16x32_bf16 v[210:213], v[92:95], v[240:243], v[210:213]
    s_waitcnt lgkmcnt(8)
    v_mfma_f32_16x16x32_bf16 v[216:219], v[100:103], v[240:243], v[216:219]
    s_waitcnt lgkmcnt(6)
    v_mfma_f32_16x16x32_bf16 v[222:225], v[108:111], v[240:243], v[222:225]
    s_waitcnt lgkmcnt(4)
    v_mfma_f32_16x16x32_bf16 v[228:231], v[116:119], v[240:243], v[228:231]
    s_waitcnt lgkmcnt(2)
    v_mfma_f32_16x16x32_bf16 v[234:237], v[124:127], v[240:243], v[234:237]
    ds_read_b64 v[240:241], v26 offset:512
    ds_read_b64 v[242:243], v27 offset:512
    v_mfma_f32_16x16x32_bf16 v[234:237], v[64:67], v[244:247], v[234:237]
    ds_read_b64 v[244:245], v24 offset:3328
    ds_read_b64 v[246:247], v25 offset:3328
    v_mfma_f32_16x16x32_bf16 v[192:195], v[64:67], v[248:251], v[192:195]
    v_mfma_f32_16x16x32_bf16 v[198:201], v[72:75], v[248:251], v[198:201]
    v_mfma_f32_16x16x32_bf16 v[204:207], v[80:83], v[248:251], v[204:207]
    v_mfma_f32_16x16x32_bf16 v[210:213], v[88:91], v[248:251], v[210:213]
    v_mfma_f32_16x16x32_bf16 v[216:219], v[96:99], v[248:251], v[216:219]
    v_mfma_f32_16x16x32_bf16 v[222:225], v[104:107], v[248:251], v[222:225]
    v_mfma_f32_16x16x32_bf16 v[228:231], v[112:115], v[248:251], v[228:231]
    v_mfma_f32_16x16x32_bf16 v[234:237], v[120:123], v[248:251], v[234:237]
    ds_read_b64 v[248:249], v28 offset:768
    ds_read_b64 v[250:251], v29 offset:768
    s_waitcnt lgkmcnt(6)
    v_mfma_f32_16x16x32_bf16 v[234:237], v[68:71], v[252:255], v[234:237]
    ds_read_b64 v[252:253], v30 offset:3072
    ds_read_b64 v[254:255], v31 offset:3072
    s_waitcnt lgkmcnt(6)
    v_mfma_f32_16x16x32_bf16 v[198:201], v[68:71], v[240:243], v[198:201]
    v_mfma_f32_16x16x32_bf16 v[204:207], v[76:79], v[240:243], v[204:207]
    v_mfma_f32_16x16x32_bf16 v[210:213], v[84:87], v[240:243], v[210:213]
    v_mfma_f32_16x16x32_bf16 v[216:219], v[92:95], v[240:243], v[216:219]
    v_mfma_f32_16x16x32_bf16 v[222:225], v[100:103], v[240:243], v[222:225]
    v_mfma_f32_16x16x32_bf16 v[228:231], v[108:111], v[240:243], v[228:231]
    v_mfma_f32_16x16x32_bf16 v[234:237], v[116:119], v[240:243], v[234:237]
    ds_read_b64 v[240:241], v30 offset:1024
    ds_read_b64 v[242:243], v31 offset:1024
    s_waitcnt lgkmcnt(6)
    v_mfma_f32_16x16x32_bf16 v[228:231], v[64:67], v[244:247], v[228:231]
    v_mfma_f32_16x16x32_bf16 v[234:237], v[72:75], v[244:247], v[234:237]
    ds_read_b64 v[244:245], v28 offset:2816
    ds_read_b64 v[246:247], v29 offset:2816
    s_waitcnt lgkmcnt(6)
    v_mfma_f32_16x16x32_bf16 v[198:201], v[64:67], v[248:251], v[198:201]
    v_mfma_f32_16x16x32_bf16 v[204:207], v[72:75], v[248:251], v[204:207]
    v_mfma_f32_16x16x32_bf16 v[210:213], v[80:83], v[248:251], v[210:213]
    v_mfma_f32_16x16x32_bf16 v[216:219], v[88:91], v[248:251], v[216:219]
    v_mfma_f32_16x16x32_bf16 v[222:225], v[96:99], v[248:251], v[222:225]
    v_mfma_f32_16x16x32_bf16 v[228:231], v[104:107], v[248:251], v[228:231]
    v_mfma_f32_16x16x32_bf16 v[234:237], v[112:115], v[248:251], v[234:237]
    ds_read_b64 v[248:249], v24 offset:1280
    ds_read_b64 v[250:251], v25 offset:1280
    s_waitcnt lgkmcnt(6)
    v_mfma_f32_16x16x32_bf16 v[228:231], v[68:71], v[252:255], v[228:231]
    v_mfma_f32_16x16x32_bf16 v[234:237], v[76:79], v[252:255], v[234:237]
    ds_read_b64 v[252:253], v26 offset:2560
    ds_read_b64 v[254:255], v27 offset:2560
    s_waitcnt lgkmcnt(6)
    v_mfma_f32_16x16x32_bf16 v[204:207], v[68:71], v[240:243], v[204:207]
    v_mfma_f32_16x16x32_bf16 v[210:213], v[76:79], v[240:243], v[210:213]
    v_mfma_f32_16x16x32_bf16 v[216:219], v[84:87], v[240:243], v[216:219]
    v_mfma_f32_16x16x32_bf16 v[222:225], v[92:95], v[240:243], v[222:225]
    v_mfma_f32_16x16x32_bf16 v[228:231], v[100:103], v[240:243], v[228:231]
    v_mfma_f32_16x16x32_bf16 v[234:237], v[108:111], v[240:243], v[234:237]
    ds_read_b64 v[240:241], v26 offset:1536
    ds_read_b64 v[242:243], v27 offset:1536
    s_waitcnt lgkmcnt(6)
    v_mfma_f32_16x16x32_bf16 v[222:225], v[64:67], v[244:247], v[222:225]
    v_mfma_f32_16x16x32_bf16 v[228:231], v[72:75], v[244:247], v[228:231]
    v_mfma_f32_16x16x32_bf16 v[234:237], v[80:83], v[244:247], v[234:237]
    ds_read_b64 v[244:245], v24 offset:2304
    ds_read_b64 v[246:247], v25 offset:2304
    s_waitcnt lgkmcnt(6)
    v_mfma_f32_16x16x32_bf16 v[204:207], v[64:67], v[248:251], v[204:207]
    v_mfma_f32_16x16x32_bf16 v[210:213], v[72:75], v[248:251], v[210:213]
    v_mfma_f32_16x16x32_bf16 v[216:219], v[80:83], v[248:251], v[216:219]
    v_mfma_f32_16x16x32_bf16 v[222:225], v[88:91], v[248:251], v[222:225]
    v_mfma_f32_16x16x32_bf16 v[228:231], v[96:99], v[248:251], v[228:231]
    v_mfma_f32_16x16x32_bf16 v[234:237], v[104:107], v[248:251], v[234:237]
    ds_read_b64 v[248:249], v28 offset:1792
    ds_read_b64 v[250:251], v29 offset:1792
    s_waitcnt lgkmcnt(6)
    v_mfma_f32_16x16x32_bf16 v[222:225], v[68:71], v[252:255], v[222:225]
    v_mfma_f32_16x16x32_bf16 v[228:231], v[76:79], v[252:255], v[228:231]
    v_mfma_f32_16x16x32_bf16 v[234:237], v[84:87], v[252:255], v[234:237]
    ds_read_b64 v[252:253], v30 offset:2048
    ds_read_b64 v[254:255], v31 offset:2048
    s_waitcnt lgkmcnt(6)
    v_mfma_f32_16x16x32_bf16 v[210:213], v[68:71], v[240:243], v[210:213]
    v_mfma_f32_16x16x32_bf16 v[216:219], v[76:79], v[240:243], v[216:219]
    v_mfma_f32_16x16x32_bf16 v[222:225], v[84:87], v[240:243], v[222:225]
    v_mfma_f32_16x16x32_bf16 v[228:231], v[92:95], v[240:243], v[228:231]
    v_mfma_f32_16x16x32_bf16 v[234:237], v[100:103], v[240:243], v[234:237]
    ds_read_b64 v[240:241], v24 offset:0
    ds_read_b64 v[242:243], v25 offset:0
    s_waitcnt lgkmcnt(6)
    v_mfma_f32_16x16x32_bf16 v[216:219], v[64:67], v[244:247], v[216:219]
    v_mfma_f32_16x16x32_bf16 v[222:225], v[72:75], v[244:247], v[222:225]
    v_mfma_f32_16x16x32_bf16 v[228:231], v[80:83], v[244:247], v[228:231]
    v_mfma_f32_16x16x32_bf16 v[234:237], v[88:91], v[244:247], v[234:237]
    ds_read_b64 v[244:245], v30 offset:3840
    ds_read_b64 v[246:247], v31 offset:3840
    s_waitcnt lgkmcnt(6)
    v_mfma_f32_16x16x32_bf16 v[210:213], v[64:67], v[248:251], v[210:213]
    v_mfma_f32_16x16x32_bf16 v[216:219], v[72:75], v[248:251], v[216:219]
    v_mfma_f32_16x16x32_bf16 v[222:225], v[80:83], v[248:251], v[222:225]
    v_mfma_f32_16x16x32_bf16 v[228:231], v[88:91], v[248:251], v[228:231]
    v_mfma_f32_16x16x32_bf16 v[234:237], v[96:99], v[248:251], v[234:237]
    ds_read_b64 v[248:249], v26 offset:256
    ds_read_b64 v[250:251], v27 offset:256
    s_waitcnt lgkmcnt(6)
    v_mfma_f32_16x16x32_bf16 v[216:219], v[68:71], v[252:255], v[216:219]
    v_mfma_f32_16x16x32_bf16 v[222:225], v[76:79], v[252:255], v[222:225]
    v_mfma_f32_16x16x32_bf16 v[228:231], v[84:87], v[252:255], v[228:231]
    v_mfma_f32_16x16x32_bf16 v[234:237], v[92:95], v[252:255], v[234:237]
    ds_read_b64 v[252:253], v28 offset:3584
    ds_read_b64 v[254:255], v29 offset:3584
    s_waitcnt lgkmcnt(6)
    v_mfma_f32_16x16x32_bf16 v[192:195], v[132:135], v[240:243], v[192:195]
    v_mfma_f32_16x16x32_bf16 v[198:201], v[140:143], v[240:243], v[198:201]
    v_mfma_f32_16x16x32_bf16 v[204:207], v[148:151], v[240:243], v[204:207]
    v_mfma_f32_16x16x32_bf16 v[210:213], v[156:159], v[240:243], v[210:213]
    v_mfma_f32_16x16x32_bf16 v[216:219], v[164:167], v[240:243], v[216:219]
    v_mfma_f32_16x16x32_bf16 v[222:225], v[172:175], v[240:243], v[222:225]
    v_mfma_f32_16x16x32_bf16 v[228:231], v[180:183], v[240:243], v[228:231]
    v_mfma_f32_16x16x32_bf16 v[234:237], v[188:191], v[240:243], v[234:237]
    ds_read_b64 v[240:241], v28 offset:512
    ds_read_b64 v[242:243], v29 offset:512
    s_waitcnt lgkmcnt(6)
    v_mfma_f32_16x16x32_bf16 v[234:237], v[128:131], v[244:247], v[234:237]
    ds_read_b64 v[244:245], v26 offset:3328
    ds_read_b64 v[246:247], v27 offset:3328
    s_waitcnt lgkmcnt(6)
    v_mfma_f32_16x16x32_bf16 v[192:195], v[128:131], v[248:251], v[192:195]
    v_mfma_f32_16x16x32_bf16 v[198:201], v[136:139], v[248:251], v[198:201]
    v_mfma_f32_16x16x32_bf16 v[204:207], v[144:147], v[248:251], v[204:207]
    v_mfma_f32_16x16x32_bf16 v[210:213], v[152:155], v[248:251], v[210:213]
    v_mfma_f32_16x16x32_bf16 v[216:219], v[160:163], v[248:251], v[216:219]
    v_mfma_f32_16x16x32_bf16 v[222:225], v[168:171], v[248:251], v[222:225]
    v_mfma_f32_16x16x32_bf16 v[228:231], v[176:179], v[248:251], v[228:231]
    v_mfma_f32_16x16x32_bf16 v[234:237], v[184:187], v[248:251], v[234:237]
    ds_read_b64 v[248:249], v30 offset:768
    ds_read_b64 v[250:251], v31 offset:768
    s_waitcnt lgkmcnt(6)
    v_mfma_f32_16x16x32_bf16 v[234:237], v[132:135], v[252:255], v[234:237]
    ds_read_b64 v[252:253], v24 offset:3072
    ds_read_b64 v[254:255], v25 offset:3072
    s_waitcnt lgkmcnt(6)
    v_mfma_f32_16x16x32_bf16 v[198:201], v[132:135], v[240:243], v[198:201]
    v_mfma_f32_16x16x32_bf16 v[204:207], v[140:143], v[240:243], v[204:207]
    v_mfma_f32_16x16x32_bf16 v[210:213], v[148:151], v[240:243], v[210:213]
    v_mfma_f32_16x16x32_bf16 v[216:219], v[156:159], v[240:243], v[216:219]
    v_mfma_f32_16x16x32_bf16 v[222:225], v[164:167], v[240:243], v[222:225]
    v_mfma_f32_16x16x32_bf16 v[228:231], v[172:175], v[240:243], v[228:231]
    v_mfma_f32_16x16x32_bf16 v[234:237], v[180:183], v[240:243], v[234:237]
    ds_read_b64 v[240:241], v24 offset:1024
    ds_read_b64 v[242:243], v25 offset:1024
    s_waitcnt lgkmcnt(6)
    v_mfma_f32_16x16x32_bf16 v[228:231], v[128:131], v[244:247], v[228:231]
    v_mfma_f32_16x16x32_bf16 v[234:237], v[136:139], v[244:247], v[234:237]
    ds_read_b64 v[244:245], v30 offset:2816
    ds_read_b64 v[246:247], v31 offset:2816
    s_waitcnt lgkmcnt(6)
    v_mfma_f32_16x16x32_bf16 v[198:201], v[128:131], v[248:251], v[198:201]
    v_mfma_f32_16x16x32_bf16 v[204:207], v[136:139], v[248:251], v[204:207]
    v_mfma_f32_16x16x32_bf16 v[210:213], v[144:147], v[248:251], v[210:213]
    v_mfma_f32_16x16x32_bf16 v[216:219], v[152:155], v[248:251], v[216:219]
    v_mfma_f32_16x16x32_bf16 v[222:225], v[160:163], v[248:251], v[222:225]
    v_mfma_f32_16x16x32_bf16 v[228:231], v[168:171], v[248:251], v[228:231]
    v_mfma_f32_16x16x32_bf16 v[234:237], v[176:179], v[248:251], v[234:237]
    ds_read_b64 v[248:249], v26 offset:1280
    ds_read_b64 v[250:251], v27 offset:1280
    s_waitcnt lgkmcnt(6)
    v_mfma_f32_16x16x32_bf16 v[228:231], v[132:135], v[252:255], v[228:231]
    v_mfma_f32_16x16x32_bf16 v[234:237], v[140:143], v[252:255], v[234:237]
    ds_read_b64 v[252:253], v28 offset:2560
    ds_read_b64 v[254:255], v29 offset:2560
    s_waitcnt lgkmcnt(6)
    v_mfma_f32_16x16x32_bf16 v[204:207], v[132:135], v[240:243], v[204:207]
    v_mfma_f32_16x16x32_bf16 v[210:213], v[140:143], v[240:243], v[210:213]
    v_mfma_f32_16x16x32_bf16 v[216:219], v[148:151], v[240:243], v[216:219]
    v_mfma_f32_16x16x32_bf16 v[222:225], v[156:159], v[240:243], v[222:225]
    v_mfma_f32_16x16x32_bf16 v[228:231], v[164:167], v[240:243], v[228:231]
    v_mfma_f32_16x16x32_bf16 v[234:237], v[172:175], v[240:243], v[234:237]
    ds_read_b64 v[240:241], v28 offset:1536
    ds_read_b64 v[242:243], v29 offset:1536
    s_waitcnt lgkmcnt(6)
    v_mfma_f32_16x16x32_bf16 v[222:225], v[128:131], v[244:247], v[222:225]
    v_mfma_f32_16x16x32_bf16 v[228:231], v[136:139], v[244:247], v[228:231]
    v_mfma_f32_16x16x32_bf16 v[234:237], v[144:147], v[244:247], v[234:237]
    ds_read_b64 v[244:245], v26 offset:2304
    ds_read_b64 v[246:247], v27 offset:2304
    s_waitcnt lgkmcnt(6)
    v_mfma_f32_16x16x32_bf16 v[204:207], v[128:131], v[248:251], v[204:207]
    v_mfma_f32_16x16x32_bf16 v[210:213], v[136:139], v[248:251], v[210:213]
    v_mfma_f32_16x16x32_bf16 v[216:219], v[144:147], v[248:251], v[216:219]
    v_mfma_f32_16x16x32_bf16 v[222:225], v[152:155], v[248:251], v[222:225]
    v_mfma_f32_16x16x32_bf16 v[228:231], v[160:163], v[248:251], v[228:231]
    v_mfma_f32_16x16x32_bf16 v[234:237], v[168:171], v[248:251], v[234:237]
    ds_read_b64 v[248:249], v30 offset:1792
    ds_read_b64 v[250:251], v31 offset:1792
    s_waitcnt lgkmcnt(6)
    v_mfma_f32_16x16x32_bf16 v[222:225], v[132:135], v[252:255], v[222:225]
    v_mfma_f32_16x16x32_bf16 v[228:231], v[140:143], v[252:255], v[228:231]
    v_mfma_f32_16x16x32_bf16 v[234:237], v[148:151], v[252:255], v[234:237]
    ds_read_b64 v[252:253], v24 offset:2048
    ds_read_b64 v[254:255], v25 offset:2048
    s_waitcnt lgkmcnt(6)
    v_mfma_f32_16x16x32_bf16 v[210:213], v[132:135], v[240:243], v[210:213]
    v_mfma_f32_16x16x32_bf16 v[216:219], v[140:143], v[240:243], v[216:219]
    v_mfma_f32_16x16x32_bf16 v[222:225], v[148:151], v[240:243], v[222:225]
    v_mfma_f32_16x16x32_bf16 v[228:231], v[156:159], v[240:243], v[228:231]
    v_mfma_f32_16x16x32_bf16 v[234:237], v[164:167], v[240:243], v[234:237]
    s_waitcnt lgkmcnt(4)
    v_mfma_f32_16x16x32_bf16 v[216:219], v[128:131], v[244:247], v[216:219]
    v_mfma_f32_16x16x32_bf16 v[222:225], v[136:139], v[244:247], v[222:225]
    v_mfma_f32_16x16x32_bf16 v[228:231], v[144:147], v[244:247], v[228:231]
    v_mfma_f32_16x16x32_bf16 v[234:237], v[152:155], v[244:247], v[234:237]
    s_waitcnt lgkmcnt(2)
    v_mfma_f32_16x16x32_bf16 v[210:213], v[128:131], v[248:251], v[210:213]
    v_mfma_f32_16x16x32_bf16 v[216:219], v[136:139], v[248:251], v[216:219]
    v_mfma_f32_16x16x32_bf16 v[222:225], v[144:147], v[248:251], v[222:225]
    v_mfma_f32_16x16x32_bf16 v[228:231], v[152:155], v[248:251], v[228:231]
    v_mfma_f32_16x16x32_bf16 v[234:237], v[160:163], v[248:251], v[234:237]
    s_waitcnt lgkmcnt(0)
    v_mfma_f32_16x16x32_bf16 v[216:219], v[132:135], v[252:255], v[216:219]
    v_mfma_f32_16x16x32_bf16 v[222:225], v[140:143], v[252:255], v[222:225]
    v_mfma_f32_16x16x32_bf16 v[228:231], v[148:151], v[252:255], v[228:231]
    v_mfma_f32_16x16x32_bf16 v[234:237], v[156:159], v[252:255], v[234:237]
    v_cvt_pk_bf16_f32 v64, v192, v193
    v_cvt_pk_bf16_f32 v65, v194, v195
    v_cvt_pk_bf16_f32 v66, v198, v199
    v_cvt_pk_bf16_f32 v67, v200, v201
    s_nop 0
    v_permlane16_swap_b32 v64, v66
    v_permlane16_swap_b32 v65, v67
    buffer_store_dwordx4 v[64:67], v33, s[48:51], s86 offen sc1
    s_add_u32 s86, s86, 65536
    v_cvt_pk_bf16_f32 v68, v204, v205
    v_cvt_pk_bf16_f32 v69, v206, v207
    v_cvt_pk_bf16_f32 v70, v210, v211
    v_cvt_pk_bf16_f32 v71, v212, v213
    s_nop 0
    v_permlane16_swap_b32 v68, v70
    v_permlane16_swap_b32 v69, v71
    buffer_store_dwordx4 v[68:71], v33, s[48:51], s86 offen sc1
    s_add_u32 s86, s86, 65536
    v_cvt_pk_bf16_f32 v72, v216, v217
    v_cvt_pk_bf16_f32 v73, v218, v219
    v_cvt_pk_bf16_f32 v74, v222, v223
    v_cvt_pk_bf16_f32 v75, v224, v225
    s_nop 0
    v_permlane16_swap_b32 v72, v74
    v_permlane16_swap_b32 v73, v75
    buffer_store_dwordx4 v[72:75], v33, s[48:51], s86 offen sc1
    s_add_u32 s86, s86, 65536
    v_cvt_pk_bf16_f32 v76, v228, v229
    v_cvt_pk_bf16_f32 v77, v230, v231
    v_cvt_pk_bf16_f32 v78, v234, v235
    v_cvt_pk_bf16_f32 v79, v236, v237
    s_nop 0
    v_permlane16_swap_b32 v76, v78
    v_permlane16_swap_b32 v77, v79
    buffer_store_dwordx4 v[76:79], v33, s[48:51], s86 offen sc1
    s_waitcnt vmcnt(0)
    s_barrier
    s_cmp_lg_u32 s68, 0
    s_cbranch_scc1 L_sig_skip_b2
    s_lshl_b32 s70, s76, 4
    s_add_u32 s70, s70, s77
    s_lshl_b32 s70, s70, 7
    s_add_u32 s70, s70, 18972672
    v_lshlrev_b32 v4, 7, v1
    v_add_u32 v4, s70, v4
    v_mov_b32 v5, s69
    s_mov_b64 s[90:91], exec
    s_mov_b64 exec, 0x1
    buffer_store_dword v5, v4, s[48:51], 0 offen sc1
    s_mov_b64 exec, s[90:91]
    s_nop 1
L_sig_skip_b2:
    v_lshrrev_b32 v2, 4, v1
    v_lshlrev_b32 v3, 1, v2
    v_and_b32 v4, 15, v1
    v_xor_b32 v3, v3, v4
    v_lshlrev_b32 v3, 4, v3
    v_lshl_add_u32 v20, v2, 8, v3
    v_xor_b32 v21, 128, v20
    v_bfe_u32 v3, v1, 2, 2
    v_and_b32 v4, 3, v1
    v_lshrrev_b32 v5, 1, v4
    s_lshl_b32 s70, s68, 2
    v_add_u32 v5, s70, v5
    v_and_b32 v6, 1, v2
    v_lshlrev_b32 v6, 3, v6
    v_lshl_or_b32 v6, v3, 1, v6
    v_xor_b32 v5, v5, v6
    v_lshlrev_b32 v5, 4, v5
    v_and_b32 v4, 1, v4
    v_lshl_add_u32 v5, v4, 3, v5
    v_lshl_add_u32 v3, v2, 3, v3
    v_lshl_add_u32 v22, v3, 8, v5
    v_xor_b32 v23, 32, v22
    v_and_b32 v4, 15, v1
    v_lshlrev_b32 v24, 12, v4
    v_lshl_add_u32 v24, v2, 4, v24
    s_lshl_b32 s83, s76, 4
    s_add_u32 s83, s83, s77
    s_lshl_b32 s83, s83, 14
    s_add_u32 s83, s83, 14680064
    s_lshl_b32 s72, s68, 12
    s_add_u32 s83, s83, s72
    v_and_b32 v2, 15, v1
    v_lshrrev_b32 v3, 4, v1
    v_and_b32 v4, 7, v2
    v_xor_b32 v4, v4, v3
    v_lshlrev_b32 v4, 4, v4
    v_lshl_add_u32 v4, v2, 7, v4
    v_xor_b32 v5, 64, v4
    v_add_u32 v4, s80, v4
    v_add_u32 v5, s80, v5
    ds_read_b128 v[40:43], v4 offset:0
    ds_read_b128 v[44:47], v5 offset:0
    ds_read_b128 v[48:51], v4 offset:2048
    ds_read_b128 v[52:55], v5 offset:2048
    s_mov_b32 s81, 0xffff0000
    s_waitcnt lgkmcnt(3)
    v_lshlrev_b32 v128, 16, v40
    v_and_b32 v129, s81, v40
    v_lshlrev_b32 v130, 16, v41
    v_and_b32 v131, s81, v41
    v_lshlrev_b32 v132, 16, v42
    v_and_b32 v133, s81, v42
    v_lshlrev_b32 v134, 16, v43
    v_and_b32 v135, s81, v43
    s_waitcnt lgkmcnt(2)
    v_lshlrev_b32 v136, 16, v44
    v_and_b32 v137, s81, v44
    v_lshlrev_b32 v138, 16, v45
    v_and_b32 v139, s81, v45
    v_lshlrev_b32 v140, 16, v46
    v_and_b32 v141, s81, v46
    v_lshlrev_b32 v142, 16, v47
    v_and_b32 v143, s81, v47
    s_waitcnt lgkmcnt(1)
    v_lshlrev_b32 v144, 16, v48
    v_and_b32 v145, s81, v48
    v_lshlrev_b32 v146, 16, v49
    v_and_b32 v147, s81, v49
    v_lshlrev_b32 v148, 16, v50
    v_and_b32 v149, s81, v50
    v_lshlrev_b32 v150, 16, v51
    v_and_b32 v151, s81, v51
    s_waitcnt lgkmcnt(0)
    v_lshlrev_b32 v152, 16, v52
    v_and_b32 v153, s81, v52
    v_lshlrev_b32 v154, 16, v53
    v_and_b32 v155, s81, v53
    v_lshlrev_b32 v156, 16, v54
    v_and_b32 v157, s81, v54
    v_lshlrev_b32 v158, 16, v55
    v_and_b32 v159, s81, v55
    s_lshl_b32 s85, s77, 19
    s_lshl_b32 s71, s68, 17
    s_add_u32 s85, s85, s71
    s_lshl_b32 s71, s76, 7
    s_add_u32 s85, s85, s71
    s_add_u32 s85, s85, 2048
    s_cmp_lg_u32 s68, 0
    s_cbranch_scc1 L_wait_skip_b2
    s_lshl_b32 s70, s76, 11
    s_add_u32 s70, s70, 18972672
    v_lshlrev_b32 v8, 7, v1
    v_add_u32 v8, s70, v8
    s_mov_b64 s[90:91], exec
    s_mov_b64 exec, 0xffff
    s_sleep 12
    s_mov_b32 s92, 0
    s_nop 1
L_poll_b2:
    buffer_load_dword v10, v8, s[48:51], 0 offen sc1
    s_waitcnt vmcnt(0)
    v_xor_b32 v10, s69, v10
    v_cmp_ne_u32 vcc, 0, v10
    s_add_u32 s92, s92, 1
    s_cmp_gt_u32 s92, 400000
    s_cbranch_scc1 L_poll_done_b2
    s_nop 1
    s_cmp_eq_u64 vcc, 0
    s_cbranch_scc1 L_poll_done_b2
    s_sleep 4
    s_branch L_poll_b2
L_poll_done_b2:
    s_mov_b64 exec, s[90:91]
    s_nop 1
L_wait_skip_b2:
    s_barrier
    s_lshl_b32 s72, s68, 12
    s_add_u32 m0, s72, 0
    s_add_u32 s71, s83, 0
    buffer_load_dwordx4 v20, s[48:51], s71 offen sc1 lds
    s_add_u32 m0, s72, 1024
    s_add_u32 s71, s83, 1024
    buffer_load_dwordx4 v20, s[48:51], s71 offen sc1 lds
    s_add_u32 m0, s72, 2048
    s_add_u32 s71, s83, 2048
    buffer_load_dwordx4 v21, s[48:51], s71 offen sc1 lds
    s_add_u32 m0, s72, 3072
    s_add_u32 s71, s83, 3072
    buffer_load_dwordx4 v21, s[48:51], s71 offen sc1 lds
    s_waitcnt vmcnt(0)
    s_barrier
    ds_read_b64_tr_b16 v[64:65], v22 offset:0
    ds_read_b64_tr_b16 v[66:67], v22 offset:1024
    ds_read_b64_tr_b16 v[68:69], v22 offset:8192
    ds_read_b64_tr_b16 v[70:71], v22 offset:9216
    ds_read_b64_tr_b16 v[72:73], v23 offset:0
    ds_read_b64_tr_b16 v[74:75], v23 offset:1024
    ds_read_b64_tr_b16 v[76:77], v23 offset:8192
    ds_read_b64_tr_b16 v[78:79], v23 offset:9216
    s_waitcnt lgkmcnt(7)
    v_lshlrev_b32 v8, 16, v64
    v_and_b32 v9, s81, v64
    v_mul_f32 v8, v8, v128
    v_mul_f32 v9, v9, v129
    v_cvt_pk_bf16_f32 v96, v8, v9
    v_lshlrev_b32 v10, 16, v65
    v_and_b32 v11, s81, v65
    v_mul_f32 v10, v10, v130
    v_mul_f32 v11, v11, v131
    v_cvt_pk_bf16_f32 v97, v10, v11
    s_waitcnt lgkmcnt(6)
    v_lshlrev_b32 v8, 16, v66
    v_and_b32 v9, s81, v66
    v_mul_f32 v8, v8, v132
    v_mul_f32 v9, v9, v133
    v_cvt_pk_bf16_f32 v98, v8, v9
    v_lshlrev_b32 v10, 16, v67
    v_and_b32 v11, s81, v67
    v_mul_f32 v10, v10, v134
    v_mul_f32 v11, v11, v135
    v_cvt_pk_bf16_f32 v99, v10, v11
    s_add_u32 s71, s85, 0
    buffer_store_dwordx4 v[96:99], v24, s[44:47], s71 offen offset:0 nt
    s_waitcnt lgkmcnt(5)
    v_lshlrev_b32 v8, 16, v68
    v_and_b32 v9, s81, v68
    v_mul_f32 v8, v8, v136
    v_mul_f32 v9, v9, v137
    v_cvt_pk_bf16_f32 v100, v8, v9
    v_lshlrev_b32 v10, 16, v69
    v_and_b32 v11, s81, v69
    v_mul_f32 v10, v10, v138
    v_mul_f32 v11, v11, v139
    v_cvt_pk_bf16_f32 v101, v10, v11
    s_waitcnt lgkmcnt(4)
    v_lshlrev_b32 v8, 16, v70
    v_and_b32 v9, s81, v70
    v_mul_f32 v8, v8, v140
    v_mul_f32 v9, v9, v141
    v_cvt_pk_bf16_f32 v102, v8, v9
    v_lshlrev_b32 v10, 16, v71
    v_and_b32 v11, s81, v71
    v_mul_f32 v10, v10, v142
    v_mul_f32 v11, v11, v143
    v_cvt_pk_bf16_f32 v103, v10, v11
    s_add_u32 s71, s85, 0
    buffer_store_dwordx4 v[100:103], v24, s[44:47], s71 offen offset:64 nt
    s_waitcnt lgkmcnt(3)
    v_lshlrev_b32 v8, 16, v72
    v_and_b32 v9, s81, v72
    v_mul_f32 v8, v8, v144
    v_mul_f32 v9, v9, v145
    v_cvt_pk_bf16_f32 v104, v8, v9
    v_lshlrev_b32 v10, 16, v73
    v_and_b32 v11, s81, v73
    v_mul_f32 v10, v10, v146
    v_mul_f32 v11, v11, v147
    v_cvt_pk_bf16_f32 v105, v10, v11
    s_waitcnt lgkmcnt(2)
    v_lshlrev_b32 v8, 16, v74
    v_and_b32 v9, s81, v74
    v_mul_f32 v8, v8, v148
    v_mul_f32 v9, v9, v149
    v_cvt_pk_bf16_f32 v106, v8, v9
    v_lshlrev_b32 v10, 16, v75
    v_and_b32 v11, s81, v75
    v_mul_f32 v10, v10, v150
    v_mul_f32 v11, v11, v151
    v_cvt_pk_bf16_f32 v107, v10, v11
    s_add_u32 s71, s85, 65536
    buffer_store_dwordx4 v[104:107], v24, s[44:47], s71 offen offset:0 nt
    s_waitcnt lgkmcnt(1)
    v_lshlrev_b32 v8, 16, v76
    v_and_b32 v9, s81, v76
    v_mul_f32 v8, v8, v152
    v_mul_f32 v9, v9, v153
    v_cvt_pk_bf16_f32 v108, v8, v9
    v_lshlrev_b32 v10, 16, v77
    v_and_b32 v11, s81, v77
    v_mul_f32 v10, v10, v154
    v_mul_f32 v11, v11, v155
    v_cvt_pk_bf16_f32 v109, v10, v11
    s_waitcnt lgkmcnt(0)
    v_lshlrev_b32 v8, 16, v78
    v_and_b32 v9, s81, v78
    v_mul_f32 v8, v8, v156
    v_mul_f32 v9, v9, v157
    v_cvt_pk_bf16_f32 v110, v8, v9
    v_lshlrev_b32 v10, 16, v79
    v_and_b32 v11, s81, v79
    v_mul_f32 v10, v10, v158
    v_mul_f32 v11, v11, v159
    v_cvt_pk_bf16_f32 v111, v10, v11
    s_add_u32 s71, s85, 65536
    buffer_store_dwordx4 v[108:111], v24, s[44:47], s71 offen offset:64 nt
L_end:
    s_endpgm
.section .rodata,"a"
.p2align 6
.amdhsa_kernel concat_heads__spectral_gfnet__ssm_conv_h3__prompt_kernel
  .amdhsa_next_free_vgpr 256
  .amdhsa_next_free_sgpr 96
  .amdhsa_accum_offset 256
  .amdhsa_group_segment_fixed_size 0
  .amdhsa_kernarg_size 96
  .amdhsa_user_sgpr_count 2
  .amdhsa_user_sgpr_kernarg_segment_ptr 1
  .amdhsa_system_sgpr_workgroup_id_x 1
  .amdhsa_float_denorm_mode_32 3
.end_amdhsa_kernel
```
